```python
import torch

def _softmax(x, axis=-1):
    return torch.softmax(x, dim=axis)
def _gelu(x):
    return torch.nn.functional.gelu(x, approximate="tanh")
def _silu(x):
    return torch.nn.functional.silu(x)
def _sigmoid(x):
    return torch.sigmoid(x)
def _layernorm(x, axis=-1, eps=1e-5):
    m = x.mean(dim=axis, keepdim=True)
    v = x.var(dim=axis, keepdim=True, unbiased=False)
    return (x - m) / torch.sqrt(v + eps)
def _scatter_add(tgt, idx, src, axis=0):
    return tgt.clone().index_add_(axis, idx, src)
def _segment_sum(src, seg, n):
    out = torch.zeros((n,) + src.shape[1:], dtype=src.dtype)
    return out.index_add_(0, seg, src)
def _pad(x, pw):
    flat = tuple(v for pair in reversed(pw) for v in pair)
    return torch.nn.functional.pad(x, flat)

kernel_name = 'standalone__gqa_block_cached__near_ridge'

def setup_inputs():

    _w = (lambda a: (lambda t: t.to(torch.bfloat16) if t.is_floating_point() else t)(torch.as_tensor(a)))
    B, Sq, D = 16, 32, 576
    Hq, Hkv, Sk, Dh = 32, 16, 32, 128
    assert Hq % Hkv == 0, (Hq, Hkv)
    return {
        "x": _w((lambda *s: torch.randn(*s, dtype=torch.bfloat16) * 0.8)(B, Sq, D)),
        "k_cache": _w((lambda *s: torch.randn(*s, dtype=torch.bfloat16) * 0.8)(B, Hkv, Sk, Dh)),
        "v_cache": _w((lambda *s: torch.randn(*s, dtype=torch.bfloat16) * 0.05)(B, Hkv, Sk, Dh)),
        "wq": _w((lambda *s: torch.randn(*s, dtype=torch.bfloat16) * 0.8)(D, Hq * Dh) * (D ** -0.5)),
        "wo": _w((lambda *s: torch.randn(*s, dtype=torch.bfloat16) * 0.05)(Hq * Dh, D) * ((Hq * Dh) ** -0.5)),
    }

def reference(x, k_cache, v_cache, wq, wo):
    B, Sq, D = x.shape
    Hq, Dh = 32, 128
    Hkv = k_cache.shape[1]
    rep = Hq // Hkv
    q = (lambda x, *d: x.permute(*d))((x @ wq).reshape(B, Sq, Hq, Dh), 0, 2, 1, 3)
    k = (lambda x, n, axis: torch.repeat_interleave(x, n, dim=axis))(k_cache, rep, axis=1)
    v = (lambda x, n, axis: torch.repeat_interleave(x, n, dim=axis))(v_cache, rep, axis=1)
    scores = torch.einsum("bhqd,bhkd->bhqk", q, k) * (Dh ** -0.5)
    p = _softmax(scores, axis=-1)
    o = torch.einsum("bhqk,bhkd->bhqd", p, v)
    return (lambda x, *d: x.permute(*d))(o, 0, 2, 1, 3).reshape(B, Sq, Hq * Dh) @ wo
```

```asm
; @launch grid=(256,1,1) block=(512,1,1) lds=163840
.amdgcn_target "amdgcn-amd-amdhsa--gfx950"
.text
.globl standalone__gqa_block_cached__near_ridge_kernel
.p2align 8
.type standalone__gqa_block_cached__near_ridge_kernel,@function
standalone__gqa_block_cached__near_ridge_kernel:
    s_load_dwordx16 s[16:31], s[0:1], 0
    s_cmp_ge_u32 s2, 256
    s_cbranch_scc1 L_end
    v_lshrrev_b32 v2, 6, v0
    v_and_b32 v1, 63, v0
    s_and_b32 s4, s2, 7
    v_readfirstlane_b32 s3, v2
    s_bfe_u32 s5, s2, 0x20003
    s_lshr_b32 s6, s2, 5
    s_lshl_b32 s7, s4, 2
    s_add_u32 s7, s7, s5
    s_lshl_b32 s14, s6, 21
    s_cmp_ge_u32 s3, 4
    s_cbranch_scc1 L_compute
    v_lshrrev_b32 v2, 4, v1
    v_and_b32 v3, 15, v1
    s_lshl_b32 s60, s3, 2
    v_lshlrev_b32 v4, 2, v2
    v_xor_b32 v4, v4, v3
    v_lshlrev_b32 v4, 4, v4
    v_add_u32 v5, s60, v2
    s_xor_b32 s61, s7, 0
    s_lshl_b32 s61, s61, 8
    v_lshl_add_u32 v10, v5, 13, v4
    v_add_u32 v10, s61, v10
    s_lshl_b32 s61, s6, 6
    s_lshl_b32 s62, s3, 4
    s_add_u32 s61, s61, s62
    v_lshrrev_b32 v6, 3, v1
    v_add_u32 v7, s61, v6
    v_mul_u32_u24 v7, 1152, v7
    v_and_b32 v8, 7, v1
    s_and_b32 s62, s60, 4
    v_or_b32 v9, s62, v2
    v_xor_b32 v9, v9, v8
    v_lshl_add_u32 v11, v9, 4, v7
    s_mul_i32 s8, s5, 1
    s_add_u32 s8, s8, s6
    s_lshl_b32 s8, s8, 2
    s_mov_b32 s62, 811796016
    s_mov_b32 s63, 103834374
    s_lshr_b64 s[62:63], s[62:63], s8
    s_and_b32 s8, s62, 15
    s_lshl_b32 s9, s3, 10
    s_lshl_b32 s10, s3, 11
    s_mov_b32 s34, 589824
    s_mov_b32 s35, 0x00020000
    s_mov_b32 s46, 4718592
    s_mov_b32 s47, 0x00020000
    s_waitcnt lgkmcnt(0)
    s_mov_b64 s[32:33], s[16:17]
    s_mov_b64 s[44:45], s[22:23]
    s_load_dword s15, s[30:31], s14
    s_add_u32 m0, s9, 73728
    s_lshl_b32 s61, s8, 19
    buffer_load_dwordx4 v10, s[44:47], s61 offen lds
    s_add_u32 m0, s10, 90112
    s_lshl_b32 s60, s8, 7
    buffer_load_dwordx4 v11, s[32:35], s60 offen lds
    s_add_u32 m0, s9, 77824
    s_add_u32 s61, s61, 131072
    buffer_load_dwordx4 v10, s[44:47], s61 offen lds
    s_add_u32 m0, s9, 81920
    s_add_u32 s61, s61, 131072
    buffer_load_dwordx4 v10, s[44:47], s61 offen lds
    s_add_u32 m0, s10, 91136
    s_add_u32 s60, s60, 9216
    buffer_load_dwordx4 v11, s[32:35], s60 offen lds
    s_add_u32 m0, s9, 86016
    s_add_u32 s61, s61, 131072
    s_add_u32 s8, s8, 1
    s_cmp_eq_u32 s8, 9
    s_cselect_b32 s8, 0, s8
    buffer_load_dwordx4 v10, s[44:47], s61 offen lds
    s_add_u32 m0, s9, 0
    s_lshl_b32 s61, s8, 19
    buffer_load_dwordx4 v10, s[44:47], s61 offen lds
    s_add_u32 m0, s10, 16384
    s_lshl_b32 s60, s8, 7
    buffer_load_dwordx4 v11, s[32:35], s60 offen lds
    s_add_u32 m0, s9, 4096
    s_add_u32 s61, s61, 131072
    buffer_load_dwordx4 v10, s[44:47], s61 offen lds
    s_add_u32 m0, s9, 8192
    s_add_u32 s61, s61, 131072
    buffer_load_dwordx4 v10, s[44:47], s61 offen lds
    s_add_u32 m0, s10, 17408
    s_add_u32 s60, s60, 9216
    buffer_load_dwordx4 v11, s[32:35], s60 offen lds
    s_add_u32 m0, s9, 12288
    s_add_u32 s61, s61, 131072
    s_add_u32 s8, s8, 1
    s_cmp_eq_u32 s8, 9
    s_cselect_b32 s8, 0, s8
    buffer_load_dwordx4 v10, s[44:47], s61 offen lds
    s_mov_b32 s38, 2097152
    s_mov_b32 s39, 0x00020000
    s_mov_b32 s42, 2097152
    s_mov_b32 s43, 0x00020000
    s_mov_b32 s50, 4718592
    s_mov_b32 s51, 0x00020000
    s_mov_b32 s54, 589824
    s_mov_b32 s55, 0x00020000
    s_mov_b32 s58, 268435456
    s_mov_b32 s59, 0x00020000
    s_mov_b64 s[36:37], s[18:19]
    s_mov_b64 s[40:41], s[20:21]
    s_mov_b64 s[48:49], s[24:25]
    s_mov_b64 s[52:53], s[26:27]
    s_mov_b64 s[56:57], s[30:31]
    s_lshl_b32 s61, s3, 3
    v_add_u32 v7, s61, v6
    v_mul_u32_u24 v7, 1152, v7
    v_and_b32 v9, 1, v2
    v_lshlrev_b32 v9, 2, v9
    v_xor_b32 v9, v9, v8
    v_lshl_add_u32 v12, v9, 4, v7
    v_xor_b32 v9, v5, v3
    v_add_u32 v7, s61, v2
    v_lshlrev_b32 v7, 8, v7
    v_lshl_add_u32 v13, v9, 4, v7
    v_lshlrev_b32 v14, 4, v1
    s_lshl_b32 s62, s6, 4
    v_add_u32 v7, s62, v5
    v_mul_u32_u24 v7, 1152, v7
    v_lshl_add_u32 v15, v3, 3, v7
    s_lshl_b32 s11, s6, 18
    s_lshl_b32 s61, s4, 14
    s_add_u32 s11, s11, s61
    s_lshr_b32 s61, s6, 2
    s_lshl_b32 s61, s61, 7
    s_lshl_b32 s62, s5, 8
    s_add_u32 s12, s61, s62
    s_and_b32 s13, s6, 3
    s_and_b32 s61, s5, 2
    s_xor_b32 s13, s13, s61
    s_xor_b32 s60, s13, s5
    s_lshl_b32 s60, s60, 10
    s_lshl_b32 s61, s3, 12
    s_add_u32 s60, s60, s61
    s_add_u32 s60, s60, 32768
    v_add_u32 v2, s60, v14
    v_mov_b32 v108, v2
    s_and_b32 s60, s2, 31
    s_lshl_b32 s60, s60, 12
    s_add_u32 s61, s14, s9
    s_add_u32 s61, s61, 131072
    s_add_u32 s29, s60, s61
    v_xor_b32 v24, 1024, v2
    s_xor_b32 s62, s60, 32768
    s_add_u32 s16, s62, s61
    v_xor_b32 v25, 2048, v2
    s_xor_b32 s62, s60, 65536
    s_add_u32 s17, s62, s61
    v_xor_b32 v26, 3072, v2
    s_xor_b32 s62, s60, 98304
    s_add_u32 s18, s62, s61
    v_lshrrev_b32 v2, 3, v1
    v_lshlrev_b32 v2, 8, v2
    v_and_b32 v3, 7, v1
    v_lshl_add_u32 v27, v3, 4, v2
    v_lshrrev_b32 v2, 4, v1
    v_lshlrev_b32 v2, 2, v2
    v_and_b32 v3, 3, v1
    v_mul_u32_u24 v3, 1152, v3
    v_add_u32 v2, v2, v3
    v_and_b32 v3, 4, v1
    v_lshl_add_u32 v30, v3, 3, v2
    s_mul_i32 s60, s7, 8192
    s_lshl_b32 s61, s3, 7
    s_add_u32 s60, s60, s61
    s_add_u32 s60, s60, s14
    s_add_u32 s19, s60, 1048576
    s_lshl_b32 s60, s6, 4
    s_lshr_b32 s61, s5, 1
    s_lshl_b32 s61, s61, 3
    s_add_u32 s60, s60, s61
    s_add_u32 s60, s60, s4
    s_mul_i32 s60, s60, 4608
    s_and_b32 s61, s5, 1
    s_lshl_b32 s61, s61, 6
    s_add_u32 s60, s60, s61
    s_lshl_b32 s61, s3, 4
    s_add_u32 s60, s60, s61
    s_add_u32 s20, s60, 1024
    v_lshrrev_b32 v2, 5, v1
    v_and_b32 v3, 31, v1
    v_lshlrev_b32 v3, 4, v3
    v_lshl_add_u32 v28, v2, 10, v3
    v_lshlrev_b32 v2, 3, v2
    v_and_b32 v3, 16, v1
    v_lshl_add_u32 v2, v3, 2, v2
    s_and_b32 s62, s3, 1
    s_lshl_b32 s63, s62, 9
    s_mul_i32 s62, s62, 36864
    v_and_b32 v3, 3, v1
    v_mul_u32_u24 v3, 1152, v3
    v_add_u32 v2, v2, v3
    v_and_b32 v3, 8, v1
    v_lshl_add_u32 v2, v3, 1, v2
    v_and_b32 v3, 4, v1
    v_lshl_add_u32 v29, v3, 3, v2
    s_mul_i32 s60, s5, 131072
    s_mul_i32 s61, s4, 16384
    s_add_u32 s60, s60, s61
    s_add_u32 s60, s60, s63
    s_add_u32 s60, s60, s14
    s_add_u32 s21, s60, 262144
    s_lshl_b32 s60, s6, 4
    s_add_u32 s60, s60, s4
    s_mul_i32 s60, s60, 4608
    s_lshr_b32 s61, s6, 2
    s_xor_b32 s61, s61, 0
    s_lshl_b32 s61, s61, 7
    s_add_u32 s60, s60, s61
    s_lshl_b32 s61, s5, 8
    s_add_u32 s60, s60, s61
    s_add_u32 s22, s60, s62
    v_and_b32 v8, 15, v1
    v_lshrrev_b32 v9, 4, v1
    v_bfe_u32 v3, v1, 2, 2
    v_xor_b32 v9, v9, v8
    v_lshlrev_b32 v9, 4, v9
    v_lshl_add_u32 v100, v3, 2, v8
    v_lshl_add_u32 v100, v100, 8, v9
    s_lshr_b32 s60, s3, 1
    s_lshl_b32 s60, s60, 13
    s_add_u32 s60, s60, 131072
    v_add_u32 v100, s60, v100
    s_lshl_b32 s60, s3, 12
    s_add_u32 s60, s60, 32768
    v_lshl_add_u32 v104, v8, 8, v9
    v_add_u32 v104, s60, v104
    v_mov_b32 v109, 0x3fff3fff
    v_mov_b32 v110, 0x3e0293ee
    v_xor_b32 v101, 64, v100
    v_xor_b32 v105, 64, v104
    v_xor_b32 v102, 128, v100
    v_xor_b32 v106, 128, v104
    v_xor_b32 v103, 192, v100
    v_xor_b32 v107, 192, v104
L_ldv0:
    s_add_u32 m0, s9, 24576
    s_lshl_b32 s61, s8, 19
    s_waitcnt vmcnt(11)
    buffer_load_dwordx4 v10, s[44:47], s61 offen lds
    s_add_u32 m0, s10, 40960
    s_lshl_b32 s60, s8, 7
    s_waitcnt vmcnt(11)
    buffer_load_dwordx4 v11, s[32:35], s60 offen lds
    s_add_u32 m0, s9, 28672
    s_add_u32 s61, s61, 131072
    s_waitcnt vmcnt(11)
    buffer_load_dwordx4 v10, s[44:47], s61 offen lds
    s_add_u32 m0, s9, 32768
    s_add_u32 s61, s61, 131072
    s_waitcnt vmcnt(11)
    buffer_load_dwordx4 v10, s[44:47], s61 offen lds
    s_add_u32 m0, s10, 41984
    s_add_u32 s60, s60, 9216
    s_waitcnt vmcnt(11)
    buffer_load_dwordx4 v11, s[32:35], s60 offen lds
    s_add_u32 m0, s9, 36864
    s_add_u32 s61, s61, 131072
    s_add_u32 s8, s8, 1
    s_cmp_eq_u32 s8, 9
    s_cselect_b32 s8, 0, s8
    s_waitcnt vmcnt(11)
    s_barrier
    buffer_load_dwordx4 v10, s[44:47], s61 offen lds
    s_and_b32 s60, s5, 1
    s_xor_b32 s60, s60, 0
    s_lshl_b32 s61, s60, 13
    s_add_u32 s61, s61, s10
    s_add_u32 m0, s61, 131072
    s_lshl_b32 s60, s60, 17
    s_lshr_b32 s61, s5, 1
    s_lshl_b32 s61, s61, 13
    s_add_u32 s60, s60, s61
    s_add_u32 s60, s60, s11
    s_waitcnt vmcnt(11)
    buffer_load_dwordx4 v13, s[36:39], s60 offen offset:0 lds
    s_waitcnt vmcnt(11)
    buffer_load_dwordx4 v13, s[36:39], s60 offen offset:1024 lds
    s_and_b32 s60, s5, 1
    s_xor_b32 s60, s60, 0
    s_lshl_b32 s61, s60, 14
    s_add_u32 s61, s61, s10
    s_add_u32 m0, s61, 98304
    s_lshl_b32 s60, s60, 17
    s_xor_b32 s61, s13, 0
    s_lshr_b32 s61, s61, 1
    s_lshl_b32 s61, s61, 13
    s_add_u32 s60, s60, s61
    s_add_u32 s60, s60, s11
    s_waitcnt vmcnt(11)
    buffer_load_dwordx4 v13, s[40:43], s60 offen offset:0 lds
    s_waitcnt vmcnt(11)
    buffer_load_dwordx4 v13, s[40:43], s60 offen offset:1024 lds
    s_add_u32 m0, s9, 49152
    s_lshl_b32 s61, s8, 19
    s_waitcnt vmcnt(11)
    buffer_load_dwordx4 v10, s[44:47], s61 offen lds
    s_add_u32 m0, s10, 65536
    s_lshl_b32 s60, s8, 7
    s_waitcnt vmcnt(11)
    s_barrier
    buffer_load_dwordx4 v11, s[32:35], s60 offen lds
    s_add_u32 m0, s9, 53248
    s_add_u32 s61, s61, 131072
    s_waitcnt vmcnt(11)
    buffer_load_dwordx4 v10, s[44:47], s61 offen lds
    s_add_u32 m0, s9, 57344
    s_add_u32 s61, s61, 131072
    s_waitcnt vmcnt(11)
    buffer_load_dwordx4 v10, s[44:47], s61 offen lds
    s_add_u32 m0, s10, 66560
    s_add_u32 s60, s60, 9216
    s_waitcnt vmcnt(11)
    buffer_load_dwordx4 v11, s[32:35], s60 offen lds
    s_add_u32 m0, s9, 61440
    s_add_u32 s61, s61, 131072
    s_add_u32 s8, s8, 1
    s_cmp_eq_u32 s8, 9
    s_cselect_b32 s8, 0, s8
    s_waitcnt vmcnt(11)
    buffer_load_dwordx4 v10, s[44:47], s61 offen lds
    s_add_u32 m0, s9, 73728
    s_lshl_b32 s61, s8, 19
    s_waitcnt vmcnt(11)
    buffer_load_dwordx4 v10, s[44:47], s61 offen lds
    s_add_u32 m0, s10, 90112
    s_lshl_b32 s60, s8, 7
    s_waitcnt vmcnt(11)
    s_waitcnt lgkmcnt(0)
    s_add_u32 s15, s15, 1013904242
    s_or_b32 s15, s15, 1
    v_and_b32 v2, 1, v1
    v_lshlrev_b32 v2, 3, v2
    v_lshlrev_b32 v2, v2, s15
    v_lshlrev_b32 v20, 0, v2
    v_and_b32 v20, 0xc000c000, v20
    v_lshlrev_b32 v21, 2, v2
    v_and_b32 v21, 0xc000c000, v21
    v_lshlrev_b32 v22, 4, v2
    v_and_b32 v22, 0xc000c000, v22
    v_lshlrev_b32 v23, 6, v2
    v_and_b32 v23, 0xc000c000, v23
    v_and_b32 v3, 3, v1
    v_lshlrev_b32 v2, 3, v3
    v_lshrrev_b32 v2, v2, s15
    v_and_b32 v2, 0xff, v2
    v_lshl_or_b32 v2, v2, 15, v2
    v_lshlrev_b32 v112, 14, v2
    v_and_b32 v112, 0x40004000, v112
    v_lshlrev_b32 v113, 12, v2
    v_and_b32 v113, 0x40004000, v113
    v_lshlrev_b32 v114, 10, v2
    v_and_b32 v114, 0x40004000, v114
    v_lshlrev_b32 v115, 8, v2
    v_and_b32 v115, 0x40004000, v115
    s_barrier
    buffer_load_dwordx4 v11, s[32:35], s60 offen lds
    s_add_u32 m0, s9, 77824
    s_add_u32 s61, s61, 131072
    s_waitcnt vmcnt(11)
    buffer_load_dwordx4 v10, s[44:47], s61 offen lds
    s_add_u32 m0, s9, 81920
    s_add_u32 s61, s61, 131072
    s_waitcnt vmcnt(11)
    buffer_load_dwordx4 v10, s[44:47], s61 offen lds
    s_add_u32 m0, s10, 91136
    s_add_u32 s60, s60, 9216
    s_waitcnt vmcnt(11)
    buffer_load_dwordx4 v11, s[32:35], s60 offen lds
    s_add_u32 m0, s9, 86016
    s_add_u32 s61, s61, 131072
    s_add_u32 s8, s8, 1
    s_cmp_eq_u32 s8, 9
    s_cselect_b32 s8, 0, s8
    s_waitcnt vmcnt(11)
    buffer_load_dwordx4 v10, s[44:47], s61 offen lds
    s_and_b32 s60, s5, 1
    s_xor_b32 s60, s60, 1
    s_lshl_b32 s61, s60, 13
    s_add_u32 s61, s61, s10
    s_add_u32 m0, s61, 131072
    s_lshl_b32 s60, s60, 17
    s_lshr_b32 s61, s5, 1
    s_lshl_b32 s61, s61, 13
    s_add_u32 s60, s60, s61
    s_add_u32 s60, s60, s11
    s_waitcnt vmcnt(11)
    buffer_load_dwordx4 v13, s[36:39], s60 offen offset:0 lds
    s_waitcnt vmcnt(11)
    buffer_load_dwordx4 v13, s[36:39], s60 offen offset:1024 lds
    s_add_u32 m0, s9, 0
    s_lshl_b32 s61, s8, 19
    s_waitcnt vmcnt(11)
    buffer_load_dwordx4 v10, s[44:47], s61 offen lds
    s_add_u32 m0, s10, 16384
    s_lshl_b32 s60, s8, 7
    s_waitcnt vmcnt(11)
    buffer_load_dwordx4 v11, s[32:35], s60 offen lds
    s_add_u32 m0, s9, 4096
    s_add_u32 s61, s61, 131072
    s_waitcnt vmcnt(11)
    buffer_load_dwordx4 v10, s[44:47], s61 offen lds
    s_add_u32 m0, s9, 8192
    s_add_u32 s61, s61, 131072
    s_waitcnt vmcnt(11)
    s_barrier
    buffer_load_dwordx4 v10, s[44:47], s61 offen lds
    s_add_u32 m0, s10, 17408
    s_add_u32 s60, s60, 9216
    s_waitcnt vmcnt(11)
    buffer_load_dwordx4 v11, s[32:35], s60 offen lds
    s_add_u32 m0, s9, 12288
    s_add_u32 s61, s61, 131072
    s_add_u32 s8, s8, 1
    s_cmp_eq_u32 s8, 9
    s_cselect_b32 s8, 0, s8
    s_waitcnt vmcnt(11)
    buffer_load_dwordx4 v10, s[44:47], s61 offen lds
    s_add_u32 m0, s9, 24576
    s_lshl_b32 s61, s8, 19
    s_waitcnt vmcnt(11)
    buffer_load_dwordx4 v10, s[44:47], s61 offen lds
    s_add_u32 m0, s10, 40960
    s_lshl_b32 s60, s8, 7
    s_waitcnt vmcnt(11)
    buffer_load_dwordx4 v11, s[32:35], s60 offen lds
    s_add_u32 m0, s9, 28672
    s_add_u32 s61, s61, 131072
    s_waitcnt vmcnt(11)
    buffer_load_dwordx4 v10, s[44:47], s61 offen lds
    s_add_u32 m0, s9, 32768
    s_add_u32 s61, s61, 131072
    s_waitcnt vmcnt(11)
    s_barrier
    buffer_load_dwordx4 v10, s[44:47], s61 offen lds
    s_add_u32 m0, s10, 41984
    s_add_u32 s60, s60, 9216
    s_waitcnt vmcnt(11)
    buffer_load_dwordx4 v11, s[32:35], s60 offen lds
    s_add_u32 m0, s9, 36864
    s_add_u32 s61, s61, 131072
    s_add_u32 s8, s8, 1
    s_cmp_eq_u32 s8, 9
    s_cselect_b32 s8, 0, s8
    s_waitcnt vmcnt(11)
    buffer_load_dwordx4 v10, s[44:47], s61 offen lds
    s_add_u32 m0, s9, 49152
    s_lshl_b32 s61, s8, 19
    s_waitcnt vmcnt(11)
    buffer_load_dwordx4 v10, s[44:47], s61 offen lds
    s_add_u32 m0, s10, 65536
    s_lshl_b32 s60, s8, 7
    s_waitcnt vmcnt(11)
    buffer_load_dwordx4 v11, s[32:35], s60 offen lds
    s_add_u32 m0, s9, 53248
    s_add_u32 s61, s61, 131072
    s_waitcnt vmcnt(11)
    buffer_load_dwordx4 v10, s[44:47], s61 offen lds
    s_add_u32 m0, s9, 57344
    s_add_u32 s61, s61, 131072
    s_waitcnt vmcnt(11)
    buffer_load_dwordx4 v10, s[44:47], s61 offen lds
    s_add_u32 m0, s10, 66560
    s_add_u32 s60, s60, 9216
    s_waitcnt vmcnt(11)
    buffer_load_dwordx4 v11, s[32:35], s60 offen lds
    s_add_u32 m0, s9, 61440
    s_add_u32 s61, s61, 131072
    s_add_u32 s8, s8, 1
    s_cmp_eq_u32 s8, 9
    s_cselect_b32 s8, 0, s8
    s_waitcnt vmcnt(11)
    s_barrier
    ds_read_b128 v[64:67], v100 offset:0
    ds_read_b128 v[68:71], v101 offset:0
    ds_read_b128 v[72:75], v102 offset:0
    ds_read_b128 v[76:79], v103 offset:0
    ds_read_b128 v[80:83], v100 offset:1024
    ds_read_b128 v[84:87], v101 offset:1024
    ds_read_b128 v[88:91], v102 offset:1024
    ds_read_b128 v[92:95], v103 offset:1024
    buffer_load_dwordx4 v10, s[44:47], s61 offen lds
    s_add_u32 m0, s9, 73728
    s_lshl_b32 s61, s8, 19
    s_waitcnt vmcnt(11)
    buffer_load_dwordx4 v10, s[44:47], s61 offen lds
    s_add_u32 m0, s10, 90112
    s_lshl_b32 s60, s8, 7
    s_waitcnt vmcnt(11)
    buffer_load_dwordx4 v11, s[32:35], s60 offen lds
    s_add_u32 m0, s9, 77824
    s_add_u32 s61, s61, 131072
    s_waitcnt vmcnt(11)
    buffer_load_dwordx4 v10, s[44:47], s61 offen lds
    s_add_u32 m0, s9, 81920
    s_add_u32 s61, s61, 131072
    s_waitcnt vmcnt(11)
    buffer_load_dwordx4 v10, s[44:47], s61 offen lds
    s_add_u32 m0, s10, 91136
    s_add_u32 s60, s60, 9216
    s_waitcnt vmcnt(11)
    buffer_load_dwordx4 v11, s[32:35], s60 offen lds
    s_add_u32 m0, s9, 86016
    s_add_u32 s61, s61, 131072
    s_waitcnt vmcnt(11)
    s_waitcnt lgkmcnt(0)
    s_barrier
    buffer_load_dwordx4 v10, s[44:47], s61 offen lds
    s_add_u32 m0, s9, 147456
    s_xor_b32 s60, s13, 0
    s_lshl_b32 s61, s4, 2
    s_add_u32 s60, s60, s61
    s_mul_i32 s60, s60, 147456
    s_xor_b32 s61, s12, 0
    s_add_u32 s60, s60, s61
    s_waitcnt vmcnt(11)
    buffer_load_dwordx4 v12, s[48:51], s60 offen lds
    s_add_u32 m0, s9, 151552
    s_add_u32 s60, s60, 36864
    s_waitcnt vmcnt(11)
    buffer_load_dwordx4 v12, s[48:51], s60 offen lds
    s_add_u32 m0, s9, 155648
    s_add_u32 s60, s60, 36864
    s_waitcnt vmcnt(11)
    buffer_load_dwordx4 v12, s[48:51], s60 offen lds
    s_add_u32 m0, s9, 159744
    s_add_u32 s60, s60, 36864
    s_waitcnt vmcnt(11)
    buffer_load_dwordx4 v12, s[48:51], s60 offen lds
    s_mul_i32 s60, s7, 147456
    s_waitcnt vmcnt(11)
    buffer_load_dwordx2 v[18:19], v15, s[48:51], s60 offen offset:1024
    s_and_b32 s60, s5, 1
    s_xor_b32 s60, s60, 1
    s_lshl_b32 s61, s60, 14
    s_add_u32 s61, s61, s10
    s_add_u32 m0, s61, 98304
    s_lshl_b32 s60, s60, 17
    s_xor_b32 s61, s13, 0
    s_lshr_b32 s61, s61, 1
    s_lshl_b32 s61, s61, 13
    s_add_u32 s60, s60, s61
    s_add_u32 s60, s60, s11
    s_waitcnt vmcnt(11)
    s_barrier
    buffer_load_dwordx4 v13, s[40:43], s60 offen offset:0 lds
    s_waitcnt vmcnt(11)
    buffer_load_dwordx4 v13, s[40:43], s60 offen offset:1024 lds
    s_waitcnt vmcnt(7)
    s_barrier
    s_barrier
    ds_read_b128 v[224:227], v104
    ds_read_b128 v[228:231], v105
    ds_read_b128 v[232:235], v106
    ds_read_b128 v[236:239], v107
    s_add_u32 m0, s9, 0
    s_xor_b32 s60, s13, 1
    s_lshl_b32 s61, s4, 2
    s_add_u32 s60, s60, s61
    s_mul_i32 s60, s60, 147456
    s_xor_b32 s61, s12, 0
    s_add_u32 s60, s60, s61
    buffer_load_dwordx4 v12, s[48:51], s60 offen lds
    s_add_u32 m0, s9, 4096
    s_add_u32 s60, s60, 36864
    buffer_load_dwordx4 v12, s[48:51], s60 offen lds
    s_add_u32 m0, s9, 8192
    s_add_u32 s60, s60, 36864
    buffer_load_dwordx4 v12, s[48:51], s60 offen lds
    s_add_u32 m0, s9, 12288
    s_add_u32 s60, s60, 36864
    buffer_load_dwordx4 v12, s[48:51], s60 offen lds
    s_waitcnt lgkmcnt(3)
    v_mfma_f32_16x16x32_bf16 v[240:243], v[64:67], v[224:227], 0
    v_mfma_f32_16x16x32_bf16 v[244:247], v[80:83], v[224:227], 0
    s_waitcnt lgkmcnt(2)
    v_mfma_f32_16x16x32_bf16 v[240:243], v[68:71], v[228:231], v[240:243]
    v_mfma_f32_16x16x32_bf16 v[244:247], v[84:87], v[228:231], v[244:247]
    s_waitcnt lgkmcnt(1)
    v_mfma_f32_16x16x32_bf16 v[240:243], v[72:75], v[232:235], v[240:243]
    v_mfma_f32_16x16x32_bf16 v[244:247], v[88:91], v[232:235], v[244:247]
    s_waitcnt lgkmcnt(0)
    v_mfma_f32_16x16x32_bf16 v[240:243], v[76:79], v[236:239], v[240:243]
    v_mfma_f32_16x16x32_bf16 v[244:247], v[92:95], v[236:239], v[244:247]
    s_nop 6
    v_max3_f32 v248, v240, v241, v242
    v_max3_f32 v249, v244, v245, v246
    v_max3_f32 v248, v248, v243, v247
    v_max_f32 v248, v248, v249
    v_mov_b32 v249, v248
    s_nop 1
    v_permlane32_swap_b32 v248, v249
    v_max_f32 v248, v248, v249
    v_mov_b32 v249, v248
    s_nop 1
    v_permlane16_swap_b32 v248, v249
    v_max_f32 v248, v248, v249
    v_mul_f32 v248, v110, v248
    v_fma_f32 v240, v240, v110, -v248
    v_fma_f32 v241, v241, v110, -v248
    v_exp_f32 v240, v240
    v_fma_f32 v242, v242, v110, -v248
    v_exp_f32 v241, v241
    v_fma_f32 v243, v243, v110, -v248
    v_exp_f32 v242, v242
    v_fma_f32 v244, v244, v110, -v248
    v_exp_f32 v243, v243
    v_fma_f32 v245, v245, v110, -v248
    v_exp_f32 v244, v244
    v_fma_f32 v246, v246, v110, -v248
    v_exp_f32 v245, v245
    v_fma_f32 v247, v247, v110, -v248
    s_and_b32 s60, s5, 1
    s_xor_b32 s60, s60, 0
    s_lshl_b32 s61, s60, 14
    s_add_u32 s61, s61, s10
    s_add_u32 m0, s61, 106496
    s_lshl_b32 s60, s60, 17
    s_xor_b32 s61, s13, 2
    s_lshr_b32 s61, s61, 1
    s_lshl_b32 s61, s61, 13
    s_add_u32 s60, s60, s61
    s_add_u32 s60, s60, s11
    s_waitcnt vmcnt(4)
    s_barrier
    buffer_load_dwordx4 v13, s[40:43], s60 offen offset:0 lds
    buffer_load_dwordx4 v13, s[40:43], s60 offen offset:1024 lds
    s_and_b32 s60, s5, 1
    s_xor_b32 s60, s60, 1
    s_lshl_b32 s61, s60, 14
    s_add_u32 s61, s61, s10
    s_add_u32 m0, s61, 106496
    s_lshl_b32 s60, s60, 17
    s_xor_b32 s61, s13, 2
    s_lshr_b32 s61, s61, 1
    s_lshl_b32 s61, s61, 13
    s_add_u32 s60, s60, s61
    s_add_u32 s60, s60, s11
    buffer_load_dwordx4 v13, s[40:43], s60 offen offset:0 lds
    buffer_load_dwordx4 v13, s[40:43], s60 offen offset:1024 lds
    v_exp_f32 v246, v246
    v_add_f32 v248, v240, v241
    v_exp_f32 v247, v247
    v_add_f32 v249, v242, v243
    v_add_f32 v250, v244, v245
    v_add_f32 v251, v246, v247
    v_add_f32 v248, v248, v249
    v_add_f32 v250, v250, v251
    v_add_f32 v248, v248, v250
    v_mov_b32 v249, v248
    s_nop 1
    v_permlane32_swap_b32 v248, v249
    v_add_f32 v248, v248, v249
    v_mov_b32 v249, v248
    s_nop 1
    v_permlane16_swap_b32 v248, v249
    v_add_f32 v248, v248, v249
    v_mul_f32 v248, 0x53800000, v248
    v_rcp_f32 v248, v248
    s_nop 0
    v_mul_f32 v240, v240, v248
    v_mul_f32 v241, v241, v248
    v_mul_f32 v242, v242, v248
    v_mul_f32 v243, v243, v248
    v_mul_f32 v244, v244, v248
    v_mul_f32 v245, v245, v248
    v_mul_f32 v246, v246, v248
    v_mul_f32 v247, v247, v248
    v_cvt_pk_bf16_f32 v248, v240, v241
    v_cvt_pk_bf16_f32 v249, v242, v243
    v_cvt_pk_bf16_f32 v250, v244, v245
    v_cvt_pk_bf16_f32 v251, v246, v247
    v_and_or_b32 v252, v248, v109, v20
    v_and_or_b32 v253, v249, v109, v21
    v_and_or_b32 v254, v250, v109, v22
    v_and_or_b32 v255, v251, v109, v23
    buffer_store_dwordx4 v[252:255], v14, s[56:59], s29 offen
    ds_write_b128 v108, v[248:251]
    s_add_u32 m0, s9, 16384
    s_mul_i32 s60, s7, 147456
    s_add_u32 s60, s60, 1024
    buffer_load_dwordx4 v12, s[48:51], s60 offen lds
    s_add_u32 m0, s9, 20480
    s_add_u32 s60, s60, 36864
    buffer_load_dwordx4 v12, s[48:51], s60 offen lds
    s_add_u32 m0, s9, 24576
    s_add_u32 s60, s60, 36864
    buffer_load_dwordx4 v12, s[48:51], s60 offen lds
    s_add_u32 m0, s9, 28672
    s_add_u32 s60, s60, 36864
    s_waitcnt vmcnt(11)
    buffer_load_dwordx4 v12, s[48:51], s60 offen lds
    s_add_u32 m0, s9, 49152
    s_xor_b32 s60, s13, 2
    s_lshl_b32 s61, s4, 2
    s_add_u32 s60, s60, s61
    s_mul_i32 s60, s60, 147456
    s_xor_b32 s61, s12, 0
    s_add_u32 s60, s60, s61
    s_waitcnt vmcnt(11)
    buffer_load_dwordx4 v12, s[48:51], s60 offen lds
    s_add_u32 m0, s9, 53248
    s_add_u32 s60, s60, 36864
    s_waitcnt vmcnt(11)
    buffer_load_dwordx4 v12, s[48:51], s60 offen lds
    s_add_u32 m0, s9, 57344
    s_add_u32 s60, s60, 36864
    s_waitcnt vmcnt(11)
    s_waitcnt lgkmcnt(0)
    s_barrier
    buffer_load_dwordx4 v12, s[48:51], s60 offen lds
    s_add_u32 m0, s9, 61440
    s_add_u32 s60, s60, 36864
    s_waitcnt vmcnt(11)
    buffer_load_dwordx4 v12, s[48:51], s60 offen lds
    s_add_u32 m0, s9, 131072
    s_xor_b32 s60, s13, 3
    s_lshl_b32 s61, s4, 2
    s_add_u32 s60, s60, s61
    s_mul_i32 s60, s60, 147456
    s_xor_b32 s61, s12, 0
    s_add_u32 s60, s60, s61
    s_waitcnt vmcnt(11)
    buffer_load_dwordx4 v12, s[48:51], s60 offen lds
    s_add_u32 m0, s9, 135168
    s_add_u32 s60, s60, 36864
    s_waitcnt vmcnt(11)
    buffer_load_dwordx4 v12, s[48:51], s60 offen lds
    s_add_u32 m0, s9, 139264
    s_add_u32 s60, s60, 36864
    s_waitcnt vmcnt(11)
    buffer_load_dwordx4 v12, s[48:51], s60 offen lds
    s_add_u32 m0, s9, 143360
    s_add_u32 s60, s60, 36864
    s_waitcnt vmcnt(11)
    buffer_load_dwordx4 v12, s[48:51], s60 offen lds
    s_add_u32 m0, s9, 65536
    s_xor_b32 s60, s13, 0
    s_lshl_b32 s61, s4, 2
    s_add_u32 s60, s60, s61
    s_mul_i32 s60, s60, 147456
    s_xor_b32 s61, s12, 128
    s_add_u32 s60, s60, s61
    s_waitcnt vmcnt(11)
    buffer_load_dwordx4 v12, s[48:51], s60 offen lds
    s_add_u32 m0, s9, 69632
    s_add_u32 s60, s60, 36864
    s_waitcnt vmcnt(11)
    buffer_load_dwordx4 v12, s[48:51], s60 offen lds
    s_add_u32 m0, s9, 73728
    s_add_u32 s60, s60, 36864
    s_waitcnt vmcnt(11)
    buffer_load_dwordx4 v12, s[48:51], s60 offen lds
    s_add_u32 m0, s9, 77824
    s_add_u32 s60, s60, 36864
    s_waitcnt vmcnt(11)
    s_barrier
    buffer_load_dwordx4 v12, s[48:51], s60 offen lds
    s_add_u32 m0, s9, 81920
    s_xor_b32 s60, s13, 1
    s_lshl_b32 s61, s4, 2
    s_add_u32 s60, s60, s61
    s_mul_i32 s60, s60, 147456
    s_xor_b32 s61, s12, 128
    s_add_u32 s60, s60, s61
    s_waitcnt vmcnt(11)
    buffer_load_dwordx4 v12, s[48:51], s60 offen lds
    s_add_u32 m0, s9, 86016
    s_add_u32 s60, s60, 36864
    s_waitcnt vmcnt(11)
    buffer_load_dwordx4 v12, s[48:51], s60 offen lds
    s_add_u32 m0, s9, 90112
    s_add_u32 s60, s60, 36864
    s_waitcnt vmcnt(11)
    buffer_load_dwordx4 v12, s[48:51], s60 offen lds
    s_add_u32 m0, s9, 94208
    s_add_u32 s60, s60, 36864
    s_waitcnt vmcnt(11)
    s_barrier
    buffer_load_dwordx4 v12, s[48:51], s60 offen lds
    s_waitcnt vmcnt(11)
    buffer_load_dwordx4 v[32:35], v14, s[56:59], s16 offen sc1
    s_waitcnt vmcnt(11)
    buffer_load_dwordx4 v[36:39], v14, s[56:59], s17 offen sc1
    s_waitcnt vmcnt(11)
    buffer_load_dwordx4 v[40:43], v14, s[56:59], s18 offen sc1
    s_add_u32 m0, s9, 147456
    s_xor_b32 s60, s13, 2
    s_lshl_b32 s61, s4, 2
    s_add_u32 s60, s60, s61
    s_mul_i32 s60, s60, 147456
    s_xor_b32 s61, s12, 128
    s_add_u32 s60, s60, s61
    s_waitcnt vmcnt(11)
    s_barrier
    buffer_load_dwordx4 v12, s[48:51], s60 offen lds
    s_add_u32 m0, s9, 151552
    s_add_u32 s60, s60, 36864
    s_waitcnt vmcnt(11)
    buffer_load_dwordx4 v12, s[48:51], s60 offen lds
    s_add_u32 m0, s9, 155648
    s_add_u32 s60, s60, 36864
    s_waitcnt vmcnt(11)
    buffer_load_dwordx4 v12, s[48:51], s60 offen lds
    s_add_u32 m0, s9, 159744
    s_add_u32 s60, s60, 36864
    s_waitcnt vmcnt(11)
    buffer_load_dwordx4 v12, s[48:51], s60 offen lds
    s_add_u32 m0, s9, 0
    s_xor_b32 s60, s13, 3
    s_lshl_b32 s61, s4, 2
    s_add_u32 s60, s60, s61
    s_mul_i32 s60, s60, 147456
    s_xor_b32 s61, s12, 128
    s_add_u32 s60, s60, s61
    s_waitcnt vmcnt(11)
    s_barrier
    buffer_load_dwordx4 v12, s[48:51], s60 offen lds
    s_add_u32 m0, s9, 4096
    s_add_u32 s60, s60, 36864
    s_waitcnt vmcnt(11)
    buffer_load_dwordx4 v12, s[48:51], s60 offen lds
    s_add_u32 m0, s9, 8192
    s_add_u32 s60, s60, 36864
    s_waitcnt vmcnt(11)
    buffer_load_dwordx4 v12, s[48:51], s60 offen lds
    s_add_u32 m0, s9, 12288
    s_add_u32 s60, s60, 36864
    s_waitcnt vmcnt(11)
    buffer_load_dwordx4 v12, s[48:51], s60 offen lds
    s_add_u32 s60, s29, 1310720
    s_waitcnt vmcnt(11)
    s_barrier
    buffer_store_dwordx4 v[252:255], v14, s[56:59], s60 offen sc1
    s_waitcnt vmcnt(9)
    s_mov_b32 s23, 0
L_pchk0:
    v_xor_b32 v48, v32, v20
    v_xor_b32 v49, v33, v21
    v_xor_b32 v50, v34, v22
    v_xor_b32 v51, v35, v23
    v_or3_b32 v2, v48, v49, v50
    v_or_b32 v2, v2, v51
    v_and_b32 v2, 0xc000c000, v2
    v_cmp_ne_u32 vcc, 0, v2
    v_xor_b32 v52, v36, v20
    v_xor_b32 v53, v37, v21
    v_xor_b32 v54, v38, v22
    v_xor_b32 v55, v39, v23
    v_or3_b32 v3, v52, v53, v54
    v_or_b32 v3, v3, v55
    v_and_b32 v3, 0xc000c000, v3
    v_cmp_ne_u32 s[24:25], 0, v3
    v_xor_b32 v56, v40, v20
    v_xor_b32 v57, v41, v21
    v_xor_b32 v58, v42, v22
    v_xor_b32 v59, v43, v23
    v_or3_b32 v4, v56, v57, v58
    v_or_b32 v4, v4, v59
    v_and_b32 v4, 0xc000c000, v4
    v_cmp_ne_u32 s[26:27], 0, v4
    s_add_u32 s23, s23, 1
    s_or_b64 s[30:31], vcc, s[24:25]
    s_or_b64 s[30:31], s[30:31], s[26:27]
    s_cbranch_scc0 L_pok0
    s_cmp_ge_u32 s23, 4096
    s_cbranch_scc1 L_pok0
    s_cmp_lg_u32 s23, 24
    s_cbranch_scc1 L_pna0
    s_add_u32 s16, s16, 1310720
    s_add_u32 s17, s17, 1310720
    s_add_u32 s18, s18, 1310720
L_pna0:
    s_cmp_eq_u64 vcc, 0
    s_cbranch_scc1 L_pk0_0
    buffer_load_dwordx4 v[32:35], v14, s[56:59], s16 offen sc1
L_pk0_0:
    s_cmp_eq_u64 s[24:25], 0
    s_cbranch_scc1 L_pk0_1
    buffer_load_dwordx4 v[36:39], v14, s[56:59], s17 offen sc1
L_pk0_1:
    s_cmp_eq_u64 s[26:27], 0
    s_cbranch_scc1 L_pk0_2
    buffer_load_dwordx4 v[40:43], v14, s[56:59], s18 offen sc1
L_pk0_2:
    s_waitcnt vmcnt(0)
    s_branch L_pchk0
L_pok0:
    ds_write_b128 v24, v[48:51]
    ds_write_b128 v25, v[52:55]
    s_waitcnt lgkmcnt(14)
    ds_write_b128 v26, v[56:59]
    s_waitcnt lgkmcnt(0)
    s_waitcnt vmcnt(5)
    s_barrier
    s_waitcnt vmcnt(1)
    s_barrier
L_ldB:
    s_cmp_ge_u32 s3, 2
    s_cbranch_scc1 L_ldl0
    s_add_u32 s61, s19, 4096
    s_movk_i32 s62, 4096
    buffer_load_dwordx4 v[32:35], v27, s[56:59], s19 offen offset:0 sc1
    buffer_load_dwordx4 v[36:39], v27, s[56:59], s19 offen offset:2048 sc1
    buffer_load_dwordx4 v[40:43], v27, s[56:59], s61 offen offset:0 sc1
    buffer_load_dwordx4 v[44:47], v27, s[56:59], s61 offen offset:2048 sc1
    s_branch L_rt8_k3
L_rt8_try:
    v_or_b32_dpp v64, v64, v64 quad_perm:[1,0,3,2] row_mask:0xf bank_mask:0xf
    v_or_b32_dpp v65, v65, v65 quad_perm:[1,0,3,2] row_mask:0xf bank_mask:0xf
    v_or_b32_dpp v66, v66, v66 quad_perm:[1,0,3,2] row_mask:0xf bank_mask:0xf
    v_or_b32_dpp v67, v67, v67 quad_perm:[1,0,3,2] row_mask:0xf bank_mask:0xf
    v_or_b32_dpp v64, v64, v64 quad_perm:[2,3,0,1] row_mask:0xf bank_mask:0xf
    v_or_b32_dpp v65, v65, v65 quad_perm:[2,3,0,1] row_mask:0xf bank_mask:0xf
    v_or_b32_dpp v66, v66, v66 quad_perm:[2,3,0,1] row_mask:0xf bank_mask:0xf
    v_or_b32_dpp v67, v67, v67 quad_perm:[2,3,0,1] row_mask:0xf bank_mask:0xf
    v_or_b32_dpp v64, v64, v64 row_half_mirror row_mask:0xf bank_mask:0xf
    v_or_b32_dpp v65, v65, v65 row_half_mirror row_mask:0xf bank_mask:0xf
    v_or_b32_dpp v66, v66, v66 row_half_mirror row_mask:0xf bank_mask:0xf
    v_or_b32_dpp v67, v67, v67 row_half_mirror row_mask:0xf bank_mask:0xf
    v_and_b32 v64, 0x40004000, v64
    v_cmp_ne_u32 vcc, 0, v64
    v_and_b32 v65, 0x40004000, v65
    v_cmp_ne_u32 s[8:9], 0, v65
    v_and_b32 v66, 0x40004000, v66
    v_cmp_ne_u32 s[10:11], 0, v66
    v_and_b32 v67, 0x40004000, v67
    v_cmp_ne_u32 s[12:13], 0, v67
    s_mov_b64 exec, vcc
    s_cbranch_execz L_rt8_k0
    buffer_load_dwordx4 v[32:35], v27, s[56:59], s19 offen offset:0 sc1
L_rt8_k0:
    s_mov_b64 exec, s[8:9]
    s_cbranch_execz L_rt8_k1
    buffer_load_dwordx4 v[36:39], v27, s[56:59], s19 offen offset:2048 sc1
L_rt8_k1:
    s_mov_b64 exec, s[10:11]
    s_cbranch_execz L_rt8_k2
    buffer_load_dwordx4 v[40:43], v27, s[56:59], s61 offen offset:0 sc1
L_rt8_k2:
    s_mov_b64 exec, s[12:13]
    s_cbranch_execz L_rt8_k3
    buffer_load_dwordx4 v[44:47], v27, s[56:59], s61 offen offset:2048 sc1
L_rt8_k3:
    s_mov_b64 exec, -1
    s_sub_u32 s62, s62, 1
    s_waitcnt vmcnt(0)
    v_xor_b32 v48, v32, v112
    v_xor_b32 v49, v33, v113
    v_xor_b32 v50, v34, v114
    v_xor_b32 v51, v35, v115
    v_or3_b32 v64, v48, v49, v50
    v_or_b32 v64, v64, v51
    v_xor_b32 v52, v36, v112
    v_xor_b32 v53, v37, v113
    v_xor_b32 v54, v38, v114
    v_xor_b32 v55, v39, v115
    v_or3_b32 v65, v52, v53, v54
    v_or_b32 v65, v65, v55
    v_xor_b32 v56, v40, v112
    v_xor_b32 v57, v41, v113
    v_xor_b32 v58, v42, v114
    v_xor_b32 v59, v43, v115
    v_or3_b32 v66, v56, v57, v58
    v_or_b32 v66, v66, v59
    v_xor_b32 v60, v44, v112
    v_xor_b32 v61, v45, v113
    v_xor_b32 v62, v46, v114
    v_xor_b32 v63, v47, v115
    v_or3_b32 v67, v60, v61, v62
    v_or_b32 v67, v67, v63
    v_or3_b32 v68, v64, v65, v66
    v_or_b32 v68, v68, v67
    v_and_b32 v68, 0x40004000, v68
    v_cmp_ne_u32 vcc, 0, v68
    s_cbranch_scc1 L_rt8_go
    s_cbranch_vccnz L_rt8_try
L_rt8_go:
    v_lshlrev_b32 v64, 16, v48
    v_and_b32 v65, 0xffff0000, v48
    v_lshlrev_b32 v66, 16, v49
    v_and_b32 v67, 0xffff0000, v49
    v_lshlrev_b32 v68, 16, v50
    v_and_b32 v69, 0xffff0000, v50
    v_lshlrev_b32 v70, 16, v51
    v_and_b32 v71, 0xffff0000, v51
    v_lshlrev_b32 v72, 16, v52
    v_and_b32 v73, 0xffff0000, v52
    v_lshlrev_b32 v74, 16, v53
    v_and_b32 v75, 0xffff0000, v53
    v_lshlrev_b32 v76, 16, v54
    v_and_b32 v77, 0xffff0000, v54
    v_lshlrev_b32 v78, 16, v55
    v_and_b32 v79, 0xffff0000, v55
    v_pk_add_f32 v[64:65], v[64:65], v[72:73]
    v_pk_add_f32 v[66:67], v[66:67], v[74:75]
    v_pk_add_f32 v[68:69], v[68:69], v[76:77]
    v_pk_add_f32 v[70:71], v[70:71], v[78:79]
    v_lshlrev_b32 v72, 16, v56
    v_and_b32 v73, 0xffff0000, v56
    v_lshlrev_b32 v74, 16, v57
    v_and_b32 v75, 0xffff0000, v57
    v_lshlrev_b32 v76, 16, v58
    v_and_b32 v77, 0xffff0000, v58
    v_lshlrev_b32 v78, 16, v59
    v_and_b32 v79, 0xffff0000, v59
    v_pk_add_f32 v[64:65], v[64:65], v[72:73]
    v_pk_add_f32 v[66:67], v[66:67], v[74:75]
    v_pk_add_f32 v[68:69], v[68:69], v[76:77]
    v_pk_add_f32 v[70:71], v[70:71], v[78:79]
    v_lshlrev_b32 v72, 16, v60
    v_and_b32 v73, 0xffff0000, v60
    v_lshlrev_b32 v74, 16, v61
    v_and_b32 v75, 0xffff0000, v61
    v_lshlrev_b32 v76, 16, v62
    v_and_b32 v77, 0xffff0000, v62
    v_lshlrev_b32 v78, 16, v63
    v_and_b32 v79, 0xffff0000, v63
    v_pk_add_f32 v[64:65], v[64:65], v[72:73]
    v_pk_add_f32 v[66:67], v[66:67], v[74:75]
    v_pk_add_f32 v[68:69], v[68:69], v[76:77]
    v_pk_add_f32 v[70:71], v[70:71], v[78:79]
    s_nop 0
    v_permlane32_swap_b32 v64, v68
    v_permlane32_swap_b32 v65, v69
    v_permlane32_swap_b32 v66, v70
    v_permlane32_swap_b32 v67, v71
    v_pk_add_f32 v[64:65], v[64:65], v[68:69]
    v_pk_add_f32 v[66:67], v[66:67], v[70:71]
    s_nop 1
    v_permlane16_swap_b32 v64, v66
    v_permlane16_swap_b32 v65, v67
    v_pk_add_f32 v[64:65], v[64:65], v[66:67]
    s_nop 1
    v_add_f32_dpp v64, v64, v64 row_ror:8 row_mask:0xf bank_mask:0xf
    v_add_f32_dpp v65, v65, v65 row_ror:8 row_mask:0xf bank_mask:0xf
    v_mul_f32 v64, 0x53800000, v64
    v_mul_f32 v65, 0x53800000, v65
    v_cvt_pk_bf16_f32 v72, v64, v65
    s_mov_b32 exec_lo, 0x00ff00ff
    s_mov_b32 exec_hi, 0x00ff00ff
    buffer_store_dword v72, v30, s[52:55], s20 offen
    s_or_b32 s8, s7, s3
    s_cbranch_scc1 L_rt8_ne
    s_mov_b64 exec, 1
    v_mov_b32 v64, s15
    buffer_store_dword v64, off, s[56:59], s14 sc1
L_rt8_ne:
    s_mov_b64 exec, -1
    s_branch L_ldend
L_ldl0:
    s_add_u32 s61, s21, 4096
    s_movk_i32 s62, 4096
    buffer_load_dwordx4 v[32:35], v28, s[56:59], s21 offen offset:0 sc1
    buffer_load_dwordx4 v[36:39], v28, s[56:59], s21 offen offset:2048 sc1
    buffer_load_dwordx4 v[40:43], v28, s[56:59], s61 offen offset:0 sc1
    buffer_load_dwordx4 v[44:47], v28, s[56:59], s61 offen offset:2048 sc1
    s_branch L_rl0_k3
L_rl0_try:
    v_or_b32_dpp v64, v64, v64 quad_perm:[1,0,3,2] row_mask:0xf bank_mask:0xf
    v_or_b32_dpp v65, v65, v65 quad_perm:[1,0,3,2] row_mask:0xf bank_mask:0xf
    v_or_b32_dpp v66, v66, v66 quad_perm:[1,0,3,2] row_mask:0xf bank_mask:0xf
    v_or_b32_dpp v67, v67, v67 quad_perm:[1,0,3,2] row_mask:0xf bank_mask:0xf
    v_or_b32_dpp v64, v64, v64 quad_perm:[2,3,0,1] row_mask:0xf bank_mask:0xf
    v_or_b32_dpp v65, v65, v65 quad_perm:[2,3,0,1] row_mask:0xf bank_mask:0xf
    v_or_b32_dpp v66, v66, v66 quad_perm:[2,3,0,1] row_mask:0xf bank_mask:0xf
    v_or_b32_dpp v67, v67, v67 quad_perm:[2,3,0,1] row_mask:0xf bank_mask:0xf
    v_or_b32_dpp v64, v64, v64 row_half_mirror row_mask:0xf bank_mask:0xf
    v_or_b32_dpp v65, v65, v65 row_half_mirror row_mask:0xf bank_mask:0xf
    v_or_b32_dpp v66, v66, v66 row_half_mirror row_mask:0xf bank_mask:0xf
    v_or_b32_dpp v67, v67, v67 row_half_mirror row_mask:0xf bank_mask:0xf
    v_and_b32 v64, 0x40004000, v64
    v_cmp_ne_u32 vcc, 0, v64
    v_and_b32 v65, 0x40004000, v65
    v_cmp_ne_u32 s[8:9], 0, v65
    v_and_b32 v66, 0x40004000, v66
    v_cmp_ne_u32 s[10:11], 0, v66
    v_and_b32 v67, 0x40004000, v67
    v_cmp_ne_u32 s[12:13], 0, v67
    s_mov_b64 exec, vcc
    s_cbranch_execz L_rl0_k0
    buffer_load_dwordx4 v[32:35], v28, s[56:59], s21 offen offset:0 sc1
L_rl0_k0:
    s_mov_b64 exec, s[8:9]
    s_cbranch_execz L_rl0_k1
    buffer_load_dwordx4 v[36:39], v28, s[56:59], s21 offen offset:2048 sc1
L_rl0_k1:
    s_mov_b64 exec, s[10:11]
    s_cbranch_execz L_rl0_k2
    buffer_load_dwordx4 v[40:43], v28, s[56:59], s61 offen offset:0 sc1
L_rl0_k2:
    s_mov_b64 exec, s[12:13]
    s_cbranch_execz L_rl0_k3
    buffer_load_dwordx4 v[44:47], v28, s[56:59], s61 offen offset:2048 sc1
L_rl0_k3:
    s_mov_b64 exec, -1
    s_sub_u32 s62, s62, 1
    s_waitcnt vmcnt(0)
    v_xor_b32 v48, v32, v112
    v_xor_b32 v49, v33, v113
    v_xor_b32 v50, v34, v114
    v_xor_b32 v51, v35, v115
    v_or3_b32 v64, v48, v49, v50
    v_or_b32 v64, v64, v51
    v_xor_b32 v52, v36, v112
    v_xor_b32 v53, v37, v113
    v_xor_b32 v54, v38, v114
    v_xor_b32 v55, v39, v115
    v_or3_b32 v65, v52, v53, v54
    v_or_b32 v65, v65, v55
    v_xor_b32 v56, v40, v112
    v_xor_b32 v57, v41, v113
    v_xor_b32 v58, v42, v114
    v_xor_b32 v59, v43, v115
    v_or3_b32 v66, v56, v57, v58
    v_or_b32 v66, v66, v59
    v_xor_b32 v60, v44, v112
    v_xor_b32 v61, v45, v113
    v_xor_b32 v62, v46, v114
    v_xor_b32 v63, v47, v115
    v_or3_b32 v67, v60, v61, v62
    v_or_b32 v67, v67, v63
    v_or3_b32 v68, v64, v65, v66
    v_or_b32 v68, v68, v67
    v_and_b32 v68, 0x40004000, v68
    v_cmp_ne_u32 vcc, 0, v68
    s_cbranch_scc1 L_rl0_go
    s_cbranch_vccnz L_rl0_try
L_rl0_go:
    v_lshlrev_b32 v64, 16, v48
    v_and_b32 v65, 0xffff0000, v48
    v_lshlrev_b32 v66, 16, v49
    v_and_b32 v67, 0xffff0000, v49
    v_lshlrev_b32 v68, 16, v50
    v_and_b32 v69, 0xffff0000, v50
    v_lshlrev_b32 v70, 16, v51
    v_and_b32 v71, 0xffff0000, v51
    v_lshlrev_b32 v72, 16, v52
    v_and_b32 v73, 0xffff0000, v52
    v_lshlrev_b32 v74, 16, v53
    v_and_b32 v75, 0xffff0000, v53
    v_lshlrev_b32 v76, 16, v54
    v_and_b32 v77, 0xffff0000, v54
    v_lshlrev_b32 v78, 16, v55
    v_and_b32 v79, 0xffff0000, v55
    v_pk_add_f32 v[64:65], v[64:65], v[72:73]
    v_pk_add_f32 v[66:67], v[66:67], v[74:75]
    v_pk_add_f32 v[68:69], v[68:69], v[76:77]
    v_pk_add_f32 v[70:71], v[70:71], v[78:79]
    v_lshlrev_b32 v72, 16, v56
    v_and_b32 v73, 0xffff0000, v56
    v_lshlrev_b32 v74, 16, v57
    v_and_b32 v75, 0xffff0000, v57
    v_lshlrev_b32 v76, 16, v58
    v_and_b32 v77, 0xffff0000, v58
    v_lshlrev_b32 v78, 16, v59
    v_and_b32 v79, 0xffff0000, v59
    v_pk_add_f32 v[64:65], v[64:65], v[72:73]
    v_pk_add_f32 v[66:67], v[66:67], v[74:75]
    v_pk_add_f32 v[68:69], v[68:69], v[76:77]
    v_pk_add_f32 v[70:71], v[70:71], v[78:79]
    v_lshlrev_b32 v72, 16, v60
    v_and_b32 v73, 0xffff0000, v60
    v_lshlrev_b32 v74, 16, v61
    v_and_b32 v75, 0xffff0000, v61
    v_lshlrev_b32 v76, 16, v62
    v_and_b32 v77, 0xffff0000, v62
    v_lshlrev_b32 v78, 16, v63
    v_and_b32 v79, 0xffff0000, v63
    v_pk_add_f32 v[64:65], v[64:65], v[72:73]
    v_pk_add_f32 v[66:67], v[66:67], v[74:75]
    v_pk_add_f32 v[68:69], v[68:69], v[76:77]
    v_pk_add_f32 v[70:71], v[70:71], v[78:79]
    s_nop 0
    v_permlane32_swap_b32 v64, v68
    v_permlane32_swap_b32 v65, v69
    v_permlane32_swap_b32 v66, v70
    v_permlane32_swap_b32 v67, v71
    v_pk_add_f32 v[64:65], v[64:65], v[68:69]
    v_pk_add_f32 v[66:67], v[66:67], v[70:71]
    v_mul_f32 v64, 0x53800000, v64
    v_mul_f32 v65, 0x53800000, v65
    v_mul_f32 v66, 0x53800000, v66
    v_mul_f32 v67, 0x53800000, v67
    v_cvt_pk_bf16_f32 v72, v64, v65
    v_cvt_pk_bf16_f32 v73, v66, v67
    buffer_store_dwordx2 v[72:73], v29, s[52:55], s22 offen
    s_mov_b64 exec, -1
L_ldend:
    s_endpgm
L_compute:
    s_sub_u32 s3, s3, 4
    s_cmp_lg_u32 s3, 0
    s_cbranch_scc1 L_nopf
    s_getpc_b64 s[10:11]
L_pc:
    s_sub_u32 s10, s10, L_pc-standalone__gqa_block_cached__near_ridge_kernel
    s_subb_u32 s11, s11, 0
    s_lshr_b32 s8, s2, 3
    s_and_b32 s8, s8, 15
    v_mul_u32_u24 v3, 16, v1
    v_add_u32 v3, s8, v3
    v_lshlrev_b32 v3, 7, v3
    v_min_u32 v3, 14704, v3
    global_load_dword v59, v3, s[10:11]
L_nopf:
    s_mov_b32 s54, 589824
    s_mov_b32 s55, 0x00020000
    s_mov_b32 s58, 268435456
    s_mov_b32 s59, 0x00020000
    s_waitcnt lgkmcnt(0)
    s_mov_b64 s[52:53], s[26:27]
    s_mov_b64 s[56:57], s[30:31]
    s_load_dword s15, s[30:31], s14
    s_and_b32 s8, s2, 31
    s_lshl_b32 s9, s8, 12
    s_lshl_b32 s10, s3, 10
    s_add_u32 s9, s9, s10
    s_add_u32 s9, s9, s14
    s_add_u32 s16, s9, 131072
    s_lshl_b32 s8, s8, 8
    s_mul_i32 s9, s3, 8192
    s_add_u32 s8, s8, s9
    s_add_u32 s8, s8, s14
    s_add_u32 s18, s8, 1048576
    s_mul_i32 s8, s5, 131072
    s_lshl_b32 s9, s4, 10
    s_add_u32 s8, s8, s9
    s_lshl_b32 s9, s3, 8
    s_add_u32 s8, s8, s9
    s_add_u32 s8, s8, s14
    s_add_u32 s17, s8, 262144
    s_bfe_u32 s21, s6, 0x10001
    v_lshrrev_b32 v2, 4, v1
    v_and_b32 v3, 15, v1
    v_lshlrev_b32 v3, 4, v3
    v_lshl_add_u32 v27, v2, 10, v3
    v_lshlrev_b32 v2, 2, v2
    s_lshl_b32 s63, s3, 8
    s_lshr_b32 s62, s3, 1
    s_mul_i32 s62, s62, 36864
    s_and_b32 s61, s3, 1
    s_lshl_b32 s61, s61, 6
    s_add_u32 s62, s62, s61
    v_and_b32 v3, 3, v1
    v_mul_u32_u24 v3, 1152, v3
    v_add_u32 v2, v2, v3
    v_and_b32 v3, 8, v1
    v_lshl_add_u32 v2, v3, 1, v2
    v_and_b32 v3, 4, v1
    v_lshl_add_u32 v28, v3, 3, v2
    s_mul_i32 s60, s5, 131072
    s_mul_i32 s61, s4, 16384
    s_add_u32 s60, s60, s61
    s_add_u32 s60, s60, s63
    s_add_u32 s60, s60, s14
    s_add_u32 s19, s60, 270336
    s_lshl_b32 s60, s6, 4
    s_add_u32 s60, s60, s4
    s_mul_i32 s60, s60, 4608
    s_lshr_b32 s61, s6, 2
    s_xor_b32 s61, s61, 1
    s_lshl_b32 s61, s61, 7
    s_add_u32 s60, s60, s61
    s_lshl_b32 s61, s5, 8
    s_add_u32 s60, s60, s61
    s_add_u32 s20, s60, s62
    s_buffer_load_dword s63, s[52:55], s20
    s_lshr_b32 s8, s3, 1
    s_and_b32 s9, s3, 1
    v_lshrrev_b32 v2, 5, v1
    v_bfe_u32 v3, v1, 2, 2
    v_bfe_u32 v4, v1, 4, 1
    v_and_b32 v5, 1, v1
    v_bfe_u32 v6, v1, 1, 1
    v_lshl_add_u32 v7, v2, 3, v3
    s_lshl_b32 s10, s9, 1
    v_xor_b32 v8, s10, v3
    v_lshlrev_b32 v8, 6, v8
    v_lshl_or_b32 v8, v7, 8, v8
    v_lshl_or_b32 v8, v4, 5, v8
    v_lshl_or_b32 v8, v5, 4, v8
    v_lshl_or_b32 v34, v6, 3, v8
    v_xor_b32 v35, 64, v34
    v_add_u32 v36, 49152, v34
    v_add_u32 v37, 49152, v35
    v_lshrrev_b32 v8, 1, v3
    v_xor_b32 v8, s9, v8
    v_lshlrev_b32 v8, 6, v8
    v_lshl_or_b32 v8, v7, 7, v8
    v_lshl_or_b32 v8, v5, 5, v8
    v_lshl_or_b32 v8, v4, 4, v8
    v_lshl_or_b32 v10, v6, 3, v8
    v_add_u32 v11, 0x10000, v10
    v_add_u32 v12, 0x20000, v10
    v_and_b32 v7, 31, v1
    v_bfe_u32 v8, v1, 1, 2
    v_lshl_or_b32 v8, v4, 2, v8
    v_xor_b32 v8, v8, v2
    v_lshlrev_b32 v8, 4, v8
    v_lshl_or_b32 v8, v7, 7, v8
    s_lshl_b32 s10, s8, 12
    s_add_u32 s10, s10, 16384
    v_add_u32 v38, s10, v8
    v_xor_b32 v39, 32, v38
    v_xor_b32 v40, 64, v38
    v_xor_b32 v41, 96, v38
    v_add_u32 v42, 49152, v38
    v_add_u32 v43, 49152, v39
    v_add_u32 v44, 49152, v40
    v_add_u32 v45, 49152, v41
    s_lshl_b32 s10, s8, 13
    s_add_u32 s10, s10, 32768
    v_and_b32 v8, 15, v1
    s_and_b32 s11, s5, 1
    s_xor_b32 s11, s11, s6
    s_and_b32 s11, s11, 3
    s_lshl_b32 s11, s11, 10
    v_lshlrev_b32 v24, 4, v1
    v_lshlrev_b32 v23, 12, v4
    v_lshl_or_b32 v23, v2, 8, v23
    v_lshl_or_b32 v23, v8, 4, v23
    v_add_u32 v23, s10, v23
    v_add_u32 v29, s11, v23
    s_lshl_b32 s11, s9, 3
    v_or_b32 v9, s11, v2
    v_xor_b32 v9, v9, v8
    v_lshlrev_b32 v9, 4, v9
    v_lshl_or_b32 v9, v7, 8, v9
    v_add_u32 v54, s10, v9
    v_xor_b32 v55, 32, v54
    v_xor_b32 v56, 64, v54
    v_xor_b32 v57, 96, v54
    v_bfe_u32 v8, v1, 2, 1
    v_bfe_u32 v9, v1, 3, 1
    v_and_b32 v3, 3, v1
    v_lshl_or_b32 v8, v4, 1, v8
    v_lshl_or_b32 v5, v8, 2, v3
    v_lshl_or_b32 v3, v9, 2, v3
    v_lshl_or_b32 v3, v8, 3, v3
    v_xor_b32 v5, v5, v2
    v_lshlrev_b32 v5, 4, v5
    v_lshl_or_b32 v5, v3, 8, v5
    s_lshl_b32 s11, s8, 14
    s_add_u32 s11, s11, 98304
    v_add_u32 v14, s11, v5
    v_xor_b32 v15, 32, v14
    v_xor_b32 v16, 64, v14
    v_xor_b32 v17, 96, v14
    v_xor_b32 v18, 128, v14
    v_xor_b32 v19, 160, v14
    v_xor_b32 v20, 192, v14
    v_xor_b32 v21, 224, v14
    v_and_b32 v3, 3, v1
    v_lshl_or_b32 v3, v2, 2, v3
    v_lshlrev_b32 v3, 4, v3
    v_lshrrev_b32 v5, 2, v7
    s_mov_b32 s11, 16384
    v_mad_u32_u24 v25, v5, s11, v3
    s_mov_b32 s11, 32768
    v_mad_u32_u24 v26, v5, s11, v3
    s_barrier
    ds_read_b128 v[224:227], v42 offset:24576
    ds_read_b64_tr_b16 v[192:193], v36 offset:24576
    ds_read_b64_tr_b16 v[194:195], v36 offset:25600
    ds_read_b64_tr_b16 v[196:197], v37 offset:24576
    ds_read_b64_tr_b16 v[198:199], v37 offset:25600
    ds_read_b128 v[228:231], v43 offset:24576
    ds_read_b64_tr_b16 v[200:201], v36 offset:28672
    ds_read_b64_tr_b16 v[202:203], v36 offset:29696
    ds_read_b64_tr_b16 v[204:205], v37 offset:28672
    ds_read_b64_tr_b16 v[206:207], v37 offset:29696
    ds_read_b128 v[232:235], v44 offset:24576
    ds_read_b64_tr_b16 v[208:209], v36 offset:32768
    ds_read_b64_tr_b16 v[210:211], v36 offset:33792
    s_waitcnt lgkmcnt(10)
    v_mfma_f32_32x32x16_bf16 v[160:175], v[192:195], v[224:227], 0
    ds_read_b64_tr_b16 v[212:213], v37 offset:32768
    ds_read_b64_tr_b16 v[214:215], v37 offset:33792
    s_waitcnt lgkmcnt(10)
    v_mfma_f32_32x32x16_bf16 v[176:191], v[196:199], v[224:227], 0
    ds_read_b128 v[236:239], v45 offset:24576
    ds_read_b64_tr_b16 v[216:217], v36 offset:36864
    ds_read_b64_tr_b16 v[218:219], v36 offset:37888
    s_waitcnt lgkmcnt(10)
    v_mfma_f32_32x32x16_bf16 v[160:175], v[200:203], v[228:231], v[160:175]
    ds_read_b64_tr_b16 v[220:221], v37 offset:36864
    ds_read_b64_tr_b16 v[222:223], v37 offset:37888
    s_waitcnt lgkmcnt(10)
    v_mfma_f32_32x32x16_bf16 v[176:191], v[204:207], v[228:231], v[176:191]
    s_waitcnt lgkmcnt(7)
    v_mfma_f32_32x32x16_bf16 v[160:175], v[208:211], v[232:235], v[160:175]
    s_waitcnt lgkmcnt(5)
    v_mfma_f32_32x32x16_bf16 v[176:191], v[212:215], v[232:235], v[176:191]
    s_waitcnt lgkmcnt(0)
    s_barrier
    ds_read_b128 v[240:243], v38 offset:0
    ds_read_b64_tr_b16 v[192:193], v34 offset:0
    ds_read_b64_tr_b16 v[194:195], v34 offset:1024
    ds_read_b64_tr_b16 v[196:197], v35 offset:0
    ds_read_b64_tr_b16 v[198:199], v35 offset:1024
    ds_read_b128 v[244:247], v39 offset:0
    ds_read_b64_tr_b16 v[200:201], v34 offset:4096
    ds_read_b64_tr_b16 v[202:203], v34 offset:5120
    v_mfma_f32_32x32x16_bf16 v[160:175], v[216:219], v[236:239], v[160:175]
    ds_read_b64_tr_b16 v[204:205], v35 offset:4096
    ds_read_b64_tr_b16 v[206:207], v35 offset:5120
    v_mfma_f32_32x32x16_bf16 v[176:191], v[220:223], v[236:239], v[176:191]
    ds_read_b128 v[248:251], v40 offset:0
    ds_read_b64_tr_b16 v[208:209], v34 offset:8192
    ds_read_b64_tr_b16 v[210:211], v34 offset:9216
    s_waitcnt lgkmcnt(10)
    v_mfma_f32_32x32x16_bf16 v[160:175], v[192:195], v[240:243], v[160:175]
    ds_read_b64_tr_b16 v[212:213], v35 offset:8192
    ds_read_b64_tr_b16 v[214:215], v35 offset:9216
    s_waitcnt lgkmcnt(10)
    v_mfma_f32_32x32x16_bf16 v[176:191], v[196:199], v[240:243], v[176:191]
    ds_read_b128 v[252:255], v41 offset:0
    ds_read_b64_tr_b16 v[216:217], v34 offset:12288
    ds_read_b64_tr_b16 v[218:219], v34 offset:13312
    s_waitcnt lgkmcnt(10)
    v_mfma_f32_32x32x16_bf16 v[160:175], v[200:203], v[244:247], v[160:175]
    ds_read_b64_tr_b16 v[220:221], v35 offset:12288
    ds_read_b64_tr_b16 v[222:223], v35 offset:13312
    s_waitcnt lgkmcnt(10)
    v_mfma_f32_32x32x16_bf16 v[176:191], v[204:207], v[244:247], v[176:191]
    s_waitcnt lgkmcnt(7)
    v_mfma_f32_32x32x16_bf16 v[160:175], v[208:211], v[248:251], v[160:175]
    s_waitcnt lgkmcnt(5)
    v_mfma_f32_32x32x16_bf16 v[176:191], v[212:215], v[248:251], v[176:191]
    s_waitcnt lgkmcnt(0)
    s_barrier
    ds_read_b128 v[224:227], v38 offset:24576
    ds_read_b64_tr_b16 v[192:193], v34 offset:24576
    ds_read_b64_tr_b16 v[194:195], v34 offset:25600
    ds_read_b64_tr_b16 v[196:197], v35 offset:24576
    ds_read_b64_tr_b16 v[198:199], v35 offset:25600
    ds_read_b128 v[228:231], v39 offset:24576
    ds_read_b64_tr_b16 v[200:201], v34 offset:28672
    ds_read_b64_tr_b16 v[202:203], v34 offset:29696
    v_mfma_f32_32x32x16_bf16 v[160:175], v[216:219], v[252:255], v[160:175]
    ds_read_b64_tr_b16 v[204:205], v35 offset:28672
    ds_read_b64_tr_b16 v[206:207], v35 offset:29696
    v_mfma_f32_32x32x16_bf16 v[176:191], v[220:223], v[252:255], v[176:191]
    ds_read_b128 v[232:235], v40 offset:24576
    ds_read_b64_tr_b16 v[208:209], v34 offset:32768
    ds_read_b64_tr_b16 v[210:211], v34 offset:33792
    s_waitcnt lgkmcnt(10)
    v_mfma_f32_32x32x16_bf16 v[160:175], v[192:195], v[224:227], v[160:175]
    ds_read_b64_tr_b16 v[212:213], v35 offset:32768
    ds_read_b64_tr_b16 v[214:215], v35 offset:33792
    s_waitcnt lgkmcnt(10)
    v_mfma_f32_32x32x16_bf16 v[176:191], v[196:199], v[224:227], v[176:191]
    ds_read_b128 v[236:239], v41 offset:24576
    ds_read_b64_tr_b16 v[216:217], v34 offset:36864
    ds_read_b64_tr_b16 v[218:219], v34 offset:37888
    s_waitcnt lgkmcnt(10)
    v_mfma_f32_32x32x16_bf16 v[160:175], v[200:203], v[228:231], v[160:175]
    ds_read_b64_tr_b16 v[220:221], v35 offset:36864
    ds_read_b64_tr_b16 v[222:223], v35 offset:37888
    s_waitcnt lgkmcnt(10)
    v_mfma_f32_32x32x16_bf16 v[176:191], v[204:207], v[228:231], v[176:191]
    s_waitcnt lgkmcnt(7)
    v_mfma_f32_32x32x16_bf16 v[160:175], v[208:211], v[232:235], v[160:175]
    s_waitcnt lgkmcnt(5)
    v_mfma_f32_32x32x16_bf16 v[176:191], v[212:215], v[232:235], v[176:191]
    s_waitcnt lgkmcnt(0)
    s_barrier
    ds_read_b128 v[240:243], v42 offset:0
    ds_read_b64_tr_b16 v[192:193], v36 offset:0
    ds_read_b64_tr_b16 v[194:195], v36 offset:1024
    ds_read_b64_tr_b16 v[196:197], v37 offset:0
    ds_read_b64_tr_b16 v[198:199], v37 offset:1024
    ds_read_b128 v[244:247], v43 offset:0
    ds_read_b64_tr_b16 v[200:201], v36 offset:4096
    ds_read_b64_tr_b16 v[202:203], v36 offset:5120
    v_mfma_f32_32x32x16_bf16 v[160:175], v[216:219], v[236:239], v[160:175]
    ds_read_b64_tr_b16 v[204:205], v37 offset:4096
    ds_read_b64_tr_b16 v[206:207], v37 offset:5120
    v_mfma_f32_32x32x16_bf16 v[176:191], v[220:223], v[236:239], v[176:191]
    ds_read_b128 v[248:251], v44 offset:0
    ds_read_b64_tr_b16 v[208:209], v36 offset:8192
    ds_read_b64_tr_b16 v[210:211], v36 offset:9216
    s_waitcnt lgkmcnt(10)
    v_mfma_f32_32x32x16_bf16 v[160:175], v[192:195], v[240:243], v[160:175]
    ds_read_b64_tr_b16 v[212:213], v37 offset:8192
    ds_read_b64_tr_b16 v[214:215], v37 offset:9216
    s_waitcnt lgkmcnt(10)
    v_mfma_f32_32x32x16_bf16 v[176:191], v[196:199], v[240:243], v[176:191]
    ds_read_b128 v[252:255], v45 offset:0
    ds_read_b64_tr_b16 v[216:217], v36 offset:12288
    ds_read_b64_tr_b16 v[218:219], v36 offset:13312
    s_waitcnt lgkmcnt(10)
    v_mfma_f32_32x32x16_bf16 v[160:175], v[200:203], v[244:247], v[160:175]
    ds_read_b64_tr_b16 v[220:221], v37 offset:12288
    ds_read_b64_tr_b16 v[222:223], v37 offset:13312
    s_waitcnt lgkmcnt(10)
    v_mfma_f32_32x32x16_bf16 v[176:191], v[204:207], v[244:247], v[176:191]
    s_waitcnt lgkmcnt(7)
    v_mfma_f32_32x32x16_bf16 v[160:175], v[208:211], v[248:251], v[160:175]
    s_waitcnt lgkmcnt(5)
    v_mfma_f32_32x32x16_bf16 v[176:191], v[212:215], v[248:251], v[176:191]
    s_waitcnt lgkmcnt(0)
    s_add_u32 s15, s15, 1013904242
    s_or_b32 s15, s15, 1
    v_and_b32 v2, 1, v1
    v_lshlrev_b32 v2, 3, v2
    v_lshlrev_b32 v2, v2, s15
    v_lshlrev_b32 v30, 0, v2
    v_and_b32 v30, 0xc000c000, v30
    v_lshlrev_b32 v31, 2, v2
    v_and_b32 v31, 0xc000c000, v31
    v_lshlrev_b32 v32, 4, v2
    v_and_b32 v32, 0xc000c000, v32
    v_lshlrev_b32 v33, 6, v2
    v_and_b32 v33, 0xc000c000, v33
    v_and_b32 v3, 3, v1
    v_lshlrev_b32 v2, 3, v3
    v_lshrrev_b32 v2, v2, s15
    v_and_b32 v2, 0xff, v2
    v_lshl_or_b32 v2, v2, 15, v2
    v_lshlrev_b32 v4, 14, v2
    v_and_b32 v4, 0x40004000, v4
    v_lshlrev_b32 v5, 12, v2
    v_and_b32 v5, 0x40004000, v5
    v_lshlrev_b32 v6, 10, v2
    v_and_b32 v6, 0x40004000, v6
    v_lshlrev_b32 v7, 8, v2
    v_and_b32 v7, 0x40004000, v7
    s_waitcnt lgkmcnt(0)
    s_barrier
    ds_read_b128 v[224:227], v42 offset:24576
    ds_read_b64_tr_b16 v[192:193], v36 offset:24576
    ds_read_b64_tr_b16 v[194:195], v36 offset:25600
    ds_read_b64_tr_b16 v[196:197], v37 offset:24576
    ds_read_b64_tr_b16 v[198:199], v37 offset:25600
    ds_read_b128 v[228:231], v43 offset:24576
    ds_read_b64_tr_b16 v[200:201], v36 offset:28672
    ds_read_b64_tr_b16 v[202:203], v36 offset:29696
    v_mfma_f32_32x32x16_bf16 v[160:175], v[216:219], v[252:255], v[160:175]
    ds_read_b64_tr_b16 v[204:205], v37 offset:28672
    ds_read_b64_tr_b16 v[206:207], v37 offset:29696
    v_mfma_f32_32x32x16_bf16 v[176:191], v[220:223], v[252:255], v[176:191]
    ds_read_b128 v[232:235], v44 offset:24576
    ds_read_b64_tr_b16 v[208:209], v36 offset:32768
    ds_read_b64_tr_b16 v[210:211], v36 offset:33792
    s_waitcnt lgkmcnt(10)
    v_mfma_f32_32x32x16_bf16 v[160:175], v[192:195], v[224:227], v[160:175]
    ds_read_b64_tr_b16 v[212:213], v37 offset:32768
    ds_read_b64_tr_b16 v[214:215], v37 offset:33792
    s_waitcnt lgkmcnt(10)
    v_mfma_f32_32x32x16_bf16 v[176:191], v[196:199], v[224:227], v[176:191]
    ds_read_b128 v[236:239], v45 offset:24576
    ds_read_b64_tr_b16 v[216:217], v36 offset:36864
    ds_read_b64_tr_b16 v[218:219], v36 offset:37888
    s_waitcnt lgkmcnt(10)
    v_mfma_f32_32x32x16_bf16 v[160:175], v[200:203], v[228:231], v[160:175]
    ds_read_b64_tr_b16 v[220:221], v37 offset:36864
    ds_read_b64_tr_b16 v[222:223], v37 offset:37888
    s_waitcnt lgkmcnt(10)
    v_mfma_f32_32x32x16_bf16 v[176:191], v[204:207], v[228:231], v[176:191]
    s_waitcnt lgkmcnt(7)
    v_mfma_f32_32x32x16_bf16 v[160:175], v[208:211], v[232:235], v[160:175]
    s_waitcnt lgkmcnt(5)
    v_mfma_f32_32x32x16_bf16 v[176:191], v[212:215], v[232:235], v[176:191]
    s_waitcnt lgkmcnt(0)
    s_barrier
    ds_read_b128 v[240:243], v38 offset:0
    ds_read_b64_tr_b16 v[192:193], v34 offset:0
    ds_read_b64_tr_b16 v[194:195], v34 offset:1024
    ds_read_b64_tr_b16 v[196:197], v35 offset:0
    ds_read_b64_tr_b16 v[198:199], v35 offset:1024
    ds_read_b128 v[244:247], v39 offset:0
    ds_read_b64_tr_b16 v[200:201], v34 offset:4096
    ds_read_b64_tr_b16 v[202:203], v34 offset:5120
    v_mfma_f32_32x32x16_bf16 v[160:175], v[216:219], v[236:239], v[160:175]
    ds_read_b64_tr_b16 v[204:205], v35 offset:4096
    ds_read_b64_tr_b16 v[206:207], v35 offset:5120
    v_mfma_f32_32x32x16_bf16 v[176:191], v[220:223], v[236:239], v[176:191]
    ds_read_b128 v[248:251], v40 offset:0
    ds_read_b64_tr_b16 v[208:209], v34 offset:8192
    ds_read_b64_tr_b16 v[210:211], v34 offset:9216
    s_waitcnt lgkmcnt(10)
    v_mfma_f32_32x32x16_bf16 v[160:175], v[192:195], v[240:243], v[160:175]
    ds_read_b64_tr_b16 v[212:213], v35 offset:8192
    ds_read_b64_tr_b16 v[214:215], v35 offset:9216
    s_waitcnt lgkmcnt(10)
    v_mfma_f32_32x32x16_bf16 v[176:191], v[196:199], v[240:243], v[176:191]
    ds_read_b128 v[252:255], v41 offset:0
    ds_read_b64_tr_b16 v[216:217], v34 offset:12288
    ds_read_b64_tr_b16 v[218:219], v34 offset:13312
    s_waitcnt lgkmcnt(10)
    v_mfma_f32_32x32x16_bf16 v[160:175], v[200:203], v[244:247], v[160:175]
    ds_read_b64_tr_b16 v[220:221], v35 offset:12288
    ds_read_b64_tr_b16 v[222:223], v35 offset:13312
    s_waitcnt lgkmcnt(10)
    v_mfma_f32_32x32x16_bf16 v[176:191], v[204:207], v[244:247], v[176:191]
    s_waitcnt lgkmcnt(7)
    v_mfma_f32_32x32x16_bf16 v[160:175], v[208:211], v[248:251], v[160:175]
    s_waitcnt lgkmcnt(5)
    v_mfma_f32_32x32x16_bf16 v[176:191], v[212:215], v[248:251], v[176:191]
    s_waitcnt lgkmcnt(0)
    s_barrier
    ds_read_b128 v[224:227], v38 offset:24576
    ds_read_b64_tr_b16 v[192:193], v34 offset:24576
    ds_read_b64_tr_b16 v[194:195], v34 offset:25600
    ds_read_b64_tr_b16 v[196:197], v35 offset:24576
    ds_read_b64_tr_b16 v[198:199], v35 offset:25600
    ds_read_b128 v[228:231], v39 offset:24576
    ds_read_b64_tr_b16 v[200:201], v34 offset:28672
    ds_read_b64_tr_b16 v[202:203], v34 offset:29696
    v_mfma_f32_32x32x16_bf16 v[160:175], v[216:219], v[252:255], v[160:175]
    ds_read_b64_tr_b16 v[204:205], v35 offset:28672
    ds_read_b64_tr_b16 v[206:207], v35 offset:29696
    v_mfma_f32_32x32x16_bf16 v[176:191], v[220:223], v[252:255], v[176:191]
    ds_read_b128 v[232:235], v40 offset:24576
    ds_read_b64_tr_b16 v[208:209], v34 offset:32768
    ds_read_b64_tr_b16 v[210:211], v34 offset:33792
    s_waitcnt lgkmcnt(10)
    v_mfma_f32_32x32x16_bf16 v[160:175], v[192:195], v[224:227], v[160:175]
    ds_read_b64_tr_b16 v[212:213], v35 offset:32768
    ds_read_b64_tr_b16 v[214:215], v35 offset:33792
    s_waitcnt lgkmcnt(10)
    v_mfma_f32_32x32x16_bf16 v[176:191], v[196:199], v[224:227], v[176:191]
    ds_read_b128 v[236:239], v41 offset:24576
    ds_read_b64_tr_b16 v[216:217], v34 offset:36864
    ds_read_b64_tr_b16 v[218:219], v34 offset:37888
    s_waitcnt lgkmcnt(10)
    v_mfma_f32_32x32x16_bf16 v[160:175], v[200:203], v[228:231], v[160:175]
    ds_read_b64_tr_b16 v[220:221], v35 offset:36864
    ds_read_b64_tr_b16 v[222:223], v35 offset:37888
    s_waitcnt lgkmcnt(10)
    v_mfma_f32_32x32x16_bf16 v[176:191], v[204:207], v[228:231], v[176:191]
    s_waitcnt lgkmcnt(7)
    v_mfma_f32_32x32x16_bf16 v[160:175], v[208:211], v[232:235], v[160:175]
    s_waitcnt lgkmcnt(5)
    v_mfma_f32_32x32x16_bf16 v[176:191], v[212:215], v[232:235], v[176:191]
    s_waitcnt lgkmcnt(0)
    s_barrier
    ds_read_b128 v[240:243], v42 offset:0
    ds_read_b64_tr_b16 v[192:193], v36 offset:0
    ds_read_b64_tr_b16 v[194:195], v36 offset:1024
    ds_read_b64_tr_b16 v[196:197], v37 offset:0
    ds_read_b64_tr_b16 v[198:199], v37 offset:1024
    ds_read_b128 v[244:247], v43 offset:0
    ds_read_b64_tr_b16 v[200:201], v36 offset:4096
    ds_read_b64_tr_b16 v[202:203], v36 offset:5120
    v_mfma_f32_32x32x16_bf16 v[160:175], v[216:219], v[236:239], v[160:175]
    ds_read_b64_tr_b16 v[204:205], v37 offset:4096
    ds_read_b64_tr_b16 v[206:207], v37 offset:5120
    v_mfma_f32_32x32x16_bf16 v[176:191], v[220:223], v[236:239], v[176:191]
    ds_read_b128 v[248:251], v44 offset:0
    ds_read_b64_tr_b16 v[208:209], v36 offset:8192
    ds_read_b64_tr_b16 v[210:211], v36 offset:9216
    s_waitcnt lgkmcnt(10)
    v_mfma_f32_32x32x16_bf16 v[160:175], v[192:195], v[240:243], v[160:175]
    ds_read_b64_tr_b16 v[212:213], v37 offset:8192
    ds_read_b64_tr_b16 v[214:215], v37 offset:9216
    s_waitcnt lgkmcnt(10)
    v_mfma_f32_32x32x16_bf16 v[176:191], v[196:199], v[240:243], v[176:191]
    ds_read_b128 v[252:255], v45 offset:0
    ds_read_b64_tr_b16 v[216:217], v36 offset:12288
    ds_read_b64_tr_b16 v[218:219], v36 offset:13312
    s_waitcnt lgkmcnt(10)
    v_mfma_f32_32x32x16_bf16 v[160:175], v[200:203], v[244:247], v[160:175]
    ds_read_b64_tr_b16 v[220:221], v37 offset:12288
    ds_read_b64_tr_b16 v[222:223], v37 offset:13312
    s_waitcnt lgkmcnt(10)
    v_mfma_f32_32x32x16_bf16 v[176:191], v[204:207], v[244:247], v[176:191]
    s_waitcnt lgkmcnt(7)
    v_mfma_f32_32x32x16_bf16 v[160:175], v[208:211], v[248:251], v[160:175]
    s_waitcnt lgkmcnt(5)
    v_mfma_f32_32x32x16_bf16 v[176:191], v[212:215], v[248:251], v[176:191]
    s_waitcnt lgkmcnt(0)
    s_barrier
    ds_read_b128 v[224:227], v42 offset:24576
    ds_read_b64_tr_b16 v[192:193], v36 offset:24576
    ds_read_b64_tr_b16 v[194:195], v36 offset:25600
    ds_read_b64_tr_b16 v[196:197], v37 offset:24576
    ds_read_b64_tr_b16 v[198:199], v37 offset:25600
    ds_read_b128 v[228:231], v43 offset:24576
    ds_read_b64_tr_b16 v[200:201], v36 offset:28672
    ds_read_b64_tr_b16 v[202:203], v36 offset:29696
    v_mfma_f32_32x32x16_bf16 v[160:175], v[216:219], v[252:255], v[160:175]
    ds_read_b64_tr_b16 v[204:205], v37 offset:28672
    ds_read_b64_tr_b16 v[206:207], v37 offset:29696
    v_mfma_f32_32x32x16_bf16 v[176:191], v[220:223], v[252:255], v[176:191]
    ds_read_b128 v[232:235], v44 offset:24576
    ds_read_b64_tr_b16 v[208:209], v36 offset:32768
    ds_read_b64_tr_b16 v[210:211], v36 offset:33792
    s_waitcnt lgkmcnt(10)
    v_mfma_f32_32x32x16_bf16 v[160:175], v[192:195], v[224:227], v[160:175]
    ds_read_b64_tr_b16 v[212:213], v37 offset:32768
    ds_read_b64_tr_b16 v[214:215], v37 offset:33792
    s_waitcnt lgkmcnt(10)
    v_mfma_f32_32x32x16_bf16 v[176:191], v[196:199], v[224:227], v[176:191]
    ds_read_b128 v[236:239], v45 offset:24576
    ds_read_b64_tr_b16 v[216:217], v36 offset:36864
    ds_read_b64_tr_b16 v[218:219], v36 offset:37888
    s_waitcnt lgkmcnt(10)
    v_mfma_f32_32x32x16_bf16 v[160:175], v[200:203], v[228:231], v[160:175]
    ds_read_b64_tr_b16 v[220:221], v37 offset:36864
    ds_read_b64_tr_b16 v[222:223], v37 offset:37888
    s_waitcnt lgkmcnt(10)
    v_mfma_f32_32x32x16_bf16 v[176:191], v[204:207], v[228:231], v[176:191]
    s_waitcnt lgkmcnt(7)
    v_mfma_f32_32x32x16_bf16 v[160:175], v[208:211], v[232:235], v[160:175]
    s_waitcnt lgkmcnt(5)
    v_mfma_f32_32x32x16_bf16 v[176:191], v[212:215], v[232:235], v[176:191]
    s_waitcnt lgkmcnt(2)
    v_mfma_f32_32x32x16_bf16 v[160:175], v[216:219], v[236:239], v[160:175]
    s_waitcnt lgkmcnt(0)
    v_mfma_f32_32x32x16_bf16 v[176:191], v[220:223], v[236:239], v[176:191]
    s_nop 9
    v_cvt_pk_bf16_f32 v224, v160, v161
    v_cvt_pk_bf16_f32 v225, v162, v163
    v_cvt_pk_bf16_f32 v226, v164, v165
    v_cvt_pk_bf16_f32 v227, v166, v167
    ds_write_b128 v54, v[224:227]
    v_cvt_pk_bf16_f32 v228, v168, v169
    v_cvt_pk_bf16_f32 v229, v170, v171
    v_cvt_pk_bf16_f32 v230, v172, v173
    v_cvt_pk_bf16_f32 v231, v174, v175
    ds_write_b128 v55, v[228:231]
    v_cvt_pk_bf16_f32 v232, v176, v177
    v_cvt_pk_bf16_f32 v233, v178, v179
    v_cvt_pk_bf16_f32 v234, v180, v181
    v_cvt_pk_bf16_f32 v235, v182, v183
    ds_write_b128 v56, v[232:235]
    v_cvt_pk_bf16_f32 v236, v184, v185
    v_cvt_pk_bf16_f32 v237, v186, v187
    v_cvt_pk_bf16_f32 v238, v188, v189
    v_cvt_pk_bf16_f32 v239, v190, v191
    ds_write_b128 v57, v[236:239]
    s_waitcnt vmcnt(0)
    s_waitcnt lgkmcnt(0)
    s_barrier
    s_barrier
    ds_read_b128 v[96:99], v14
    ds_read_b64_tr_b16 v[192:193], v12 offset:16384
    ds_read_b64_tr_b16 v[194:195], v12 offset:16896
    ds_read_b128 v[100:103], v15
    ds_read_b64_tr_b16 v[196:197], v12 offset:18432
    ds_read_b64_tr_b16 v[198:199], v12 offset:18944
    ds_read_b128 v[104:107], v16
    ds_read_b64_tr_b16 v[200:201], v12 offset:20480
    ds_read_b64_tr_b16 v[202:203], v12 offset:20992
    ds_read_b128 v[108:111], v17
    ds_read_b64_tr_b16 v[204:205], v12 offset:22528
    ds_read_b64_tr_b16 v[206:207], v12 offset:23040
    ds_read_b128 v[112:115], v18
    ds_read_b64_tr_b16 v[208:209], v12 offset:24576
    ds_read_b64_tr_b16 v[210:211], v12 offset:25088
    s_waitcnt lgkmcnt(12)
    v_mfma_f32_32x32x16_bf16 v[160:175], v[96:99], v[192:195], 0
    ds_read_b128 v[116:119], v19
    ds_read_b64_tr_b16 v[212:213], v12 offset:26624
    ds_read_b64_tr_b16 v[214:215], v12 offset:27136
    s_waitcnt lgkmcnt(12)
    v_mfma_f32_32x32x16_bf16 v[160:175], v[100:103], v[196:199], v[160:175]
    ds_read_b128 v[120:123], v20
    ds_read_b64_tr_b16 v[216:217], v12 offset:28672
    ds_read_b64_tr_b16 v[218:219], v12 offset:29184
    s_waitcnt lgkmcnt(12)
    v_mfma_f32_32x32x16_bf16 v[160:175], v[104:107], v[200:203], v[160:175]
    ds_read_b128 v[124:127], v21
    ds_read_b64_tr_b16 v[220:221], v12 offset:30720
    ds_read_b64_tr_b16 v[222:223], v12 offset:31232
    s_waitcnt lgkmcnt(12)
    v_mfma_f32_32x32x16_bf16 v[160:175], v[108:111], v[204:207], v[160:175]
    s_barrier
    ds_read_b64_tr_b16 v[192:193], v10 offset:0
    ds_read_b64_tr_b16 v[194:195], v10 offset:512
    s_waitcnt lgkmcnt(11)
    v_mfma_f32_32x32x16_bf16 v[160:175], v[112:115], v[208:211], v[160:175]
    ds_read_b64_tr_b16 v[196:197], v10 offset:2048
    ds_read_b64_tr_b16 v[198:199], v10 offset:2560
    s_waitcnt lgkmcnt(10)
    v_mfma_f32_32x32x16_bf16 v[160:175], v[116:119], v[212:215], v[160:175]
    ds_read_b64_tr_b16 v[200:201], v10 offset:4096
    ds_read_b64_tr_b16 v[202:203], v10 offset:4608
    s_waitcnt lgkmcnt(9)
    v_mfma_f32_32x32x16_bf16 v[160:175], v[120:123], v[216:219], v[160:175]
    ds_read_b64_tr_b16 v[204:205], v10 offset:6144
    ds_read_b64_tr_b16 v[206:207], v10 offset:6656
    s_waitcnt lgkmcnt(8)
    v_mfma_f32_32x32x16_bf16 v[160:175], v[124:127], v[220:223], v[160:175]
    ds_read_b64_tr_b16 v[208:209], v10 offset:8192
    ds_read_b64_tr_b16 v[210:211], v10 offset:8704
    s_waitcnt lgkmcnt(8)
    v_mfma_f32_32x32x16_bf16 v[176:191], v[96:99], v[192:195], 0
    ds_read_b64_tr_b16 v[212:213], v10 offset:10240
    ds_read_b64_tr_b16 v[214:215], v10 offset:10752
    s_waitcnt lgkmcnt(8)
    v_mfma_f32_32x32x16_bf16 v[176:191], v[100:103], v[196:199], v[176:191]
    ds_read_b64_tr_b16 v[216:217], v10 offset:12288
    ds_read_b64_tr_b16 v[218:219], v10 offset:12800
    s_nop 1
    v_cvt_pk_bf16_f32 v64, v160, v161
    v_cvt_pk_bf16_f32 v65, v162, v163
    v_cvt_pk_bf16_f32 v66, v164, v165
    v_cvt_pk_bf16_f32 v67, v166, v167
    s_waitcnt lgkmcnt(8)
    v_mfma_f32_32x32x16_bf16 v[176:191], v[104:107], v[200:203], v[176:191]
    ds_read_b64_tr_b16 v[220:221], v10 offset:14336
    ds_read_b64_tr_b16 v[222:223], v10 offset:14848
    v_cvt_pk_bf16_f32 v68, v168, v169
    v_cvt_pk_bf16_f32 v69, v170, v171
    v_cvt_pk_bf16_f32 v70, v172, v173
    v_cvt_pk_bf16_f32 v71, v174, v175
    s_waitcnt lgkmcnt(8)
    v_mfma_f32_32x32x16_bf16 v[176:191], v[108:111], v[204:207], v[176:191]
    s_barrier
    ds_read_b128 v[128:131], v14 offset:8192
    ds_read_b64_tr_b16 v[192:193], v10 offset:16384
    ds_read_b64_tr_b16 v[194:195], v10 offset:16896
    s_waitcnt lgkmcnt(9)
    v_mfma_f32_32x32x16_bf16 v[176:191], v[112:115], v[208:211], v[176:191]
    ds_read_b128 v[132:135], v15 offset:8192
    ds_read_b64_tr_b16 v[196:197], v10 offset:18432
    ds_read_b64_tr_b16 v[198:199], v10 offset:18944
    s_waitcnt lgkmcnt(10)
    v_mfma_f32_32x32x16_bf16 v[176:191], v[116:119], v[212:215], v[176:191]
    ds_read_b128 v[136:139], v16 offset:8192
    ds_read_b64_tr_b16 v[200:201], v10 offset:20480
    ds_read_b64_tr_b16 v[202:203], v10 offset:20992
    s_waitcnt lgkmcnt(11)
    v_mfma_f32_32x32x16_bf16 v[176:191], v[120:123], v[216:219], v[176:191]
    ds_read_b128 v[140:143], v17 offset:8192
    ds_read_b64_tr_b16 v[204:205], v10 offset:22528
    ds_read_b64_tr_b16 v[206:207], v10 offset:23040
    s_waitcnt lgkmcnt(12)
    v_mfma_f32_32x32x16_bf16 v[176:191], v[124:127], v[220:223], v[176:191]
    ds_read_b128 v[144:147], v18 offset:8192
    ds_read_b64_tr_b16 v[208:209], v10 offset:24576
    ds_read_b64_tr_b16 v[210:211], v10 offset:25088
    s_cmp_eq_u32 s21, 1
    s_cbranch_scc1 L_t8b
    s_waitcnt lgkmcnt(12)
    v_mfma_f32_32x32x16_bf16 v[160:175], v[96:99], v[192:195], 0
    ds_read_b128 v[148:151], v19 offset:8192
    ds_read_b64_tr_b16 v[212:213], v10 offset:26624
    ds_read_b64_tr_b16 v[214:215], v10 offset:27136
    s_waitcnt lgkmcnt(12)
    v_mfma_f32_32x32x16_bf16 v[160:175], v[100:103], v[196:199], v[160:175]
    ds_read_b128 v[152:155], v20 offset:8192
    ds_read_b64_tr_b16 v[216:217], v10 offset:28672
    ds_read_b64_tr_b16 v[218:219], v10 offset:29184
    v_cvt_pk_bf16_f32 v72, v176, v177
    v_cvt_pk_bf16_f32 v73, v178, v179
    v_cvt_pk_bf16_f32 v74, v180, v181
    v_cvt_pk_bf16_f32 v75, v182, v183
    s_waitcnt lgkmcnt(12)
    v_mfma_f32_32x32x16_bf16 v[160:175], v[104:107], v[200:203], v[160:175]
    ds_read_b128 v[156:159], v21 offset:8192
    ds_read_b64_tr_b16 v[220:221], v10 offset:30720
    ds_read_b64_tr_b16 v[222:223], v10 offset:31232
    v_cvt_pk_bf16_f32 v76, v184, v185
    v_cvt_pk_bf16_f32 v77, v186, v187
    v_cvt_pk_bf16_f32 v78, v188, v189
    v_cvt_pk_bf16_f32 v79, v190, v191
    s_waitcnt lgkmcnt(12)
    v_mfma_f32_32x32x16_bf16 v[160:175], v[108:111], v[204:207], v[160:175]
    s_barrier
    ds_read_b64_tr_b16 v[192:193], v10 offset:49152
    ds_read_b64_tr_b16 v[194:195], v10 offset:49664
    s_waitcnt lgkmcnt(11)
    v_mfma_f32_32x32x16_bf16 v[160:175], v[112:115], v[208:211], v[160:175]
    ds_read_b64_tr_b16 v[196:197], v10 offset:51200
    ds_read_b64_tr_b16 v[198:199], v10 offset:51712
    ds_read_b128 v[224:227], v29 offset:0
    ds_read_b128 v[228:231], v29 offset:512
    s_waitcnt lgkmcnt(12)
    v_mfma_f32_32x32x16_bf16 v[160:175], v[116:119], v[212:215], v[160:175]
    ds_read_b64_tr_b16 v[200:201], v10 offset:53248
    ds_read_b64_tr_b16 v[202:203], v10 offset:53760
    s_waitcnt lgkmcnt(11)
    v_mfma_f32_32x32x16_bf16 v[160:175], v[120:123], v[216:219], v[160:175]
    ds_read_b64_tr_b16 v[204:205], v10 offset:55296
    ds_read_b64_tr_b16 v[206:207], v10 offset:55808
    s_waitcnt lgkmcnt(10)
    v_mfma_f32_32x32x16_bf16 v[160:175], v[124:127], v[220:223], v[160:175]
    ds_read_b64_tr_b16 v[208:209], v10 offset:57344
    ds_read_b64_tr_b16 v[210:211], v10 offset:57856
    s_branch L_t8j
L_t8b:
    s_waitcnt lgkmcnt(12)
    s_nop 7
    v_mfma_f32_32x32x16_bf16 v[160:175], v[128:131], v[192:195], 0
    ds_read_b128 v[148:151], v19 offset:8192
    ds_read_b64_tr_b16 v[212:213], v10 offset:26624
    ds_read_b64_tr_b16 v[214:215], v10 offset:27136
    s_waitcnt lgkmcnt(12)
    v_mfma_f32_32x32x16_bf16 v[160:175], v[132:135], v[196:199], v[160:175]
    ds_read_b128 v[152:155], v20 offset:8192
    ds_read_b64_tr_b16 v[216:217], v10 offset:28672
    ds_read_b64_tr_b16 v[218:219], v10 offset:29184
    v_cvt_pk_bf16_f32 v72, v176, v177
    v_cvt_pk_bf16_f32 v73, v178, v179
    v_cvt_pk_bf16_f32 v74, v180, v181
    v_cvt_pk_bf16_f32 v75, v182, v183
    s_waitcnt lgkmcnt(12)
    v_mfma_f32_32x32x16_bf16 v[160:175], v[136:139], v[200:203], v[160:175]
    ds_read_b128 v[156:159], v21 offset:8192
    ds_read_b64_tr_b16 v[220:221], v10 offset:30720
    ds_read_b64_tr_b16 v[222:223], v10 offset:31232
    v_cvt_pk_bf16_f32 v76, v184, v185
    v_cvt_pk_bf16_f32 v77, v186, v187
    v_cvt_pk_bf16_f32 v78, v188, v189
    v_cvt_pk_bf16_f32 v79, v190, v191
    s_waitcnt lgkmcnt(12)
    v_mfma_f32_32x32x16_bf16 v[160:175], v[140:143], v[204:207], v[160:175]
    s_barrier
    ds_read_b64_tr_b16 v[192:193], v10 offset:49152
    ds_read_b64_tr_b16 v[194:195], v10 offset:49664
    s_waitcnt lgkmcnt(11)
    v_mfma_f32_32x32x16_bf16 v[160:175], v[144:147], v[208:211], v[160:175]
    ds_read_b64_tr_b16 v[196:197], v10 offset:51200
    ds_read_b64_tr_b16 v[198:199], v10 offset:51712
    ds_read_b128 v[224:227], v29 offset:0
    ds_read_b128 v[228:231], v29 offset:512
    s_waitcnt lgkmcnt(12)
    v_mfma_f32_32x32x16_bf16 v[160:175], v[148:151], v[212:215], v[160:175]
    ds_read_b64_tr_b16 v[200:201], v10 offset:53248
    ds_read_b64_tr_b16 v[202:203], v10 offset:53760
    s_waitcnt lgkmcnt(11)
    v_mfma_f32_32x32x16_bf16 v[160:175], v[152:155], v[216:219], v[160:175]
    ds_read_b64_tr_b16 v[204:205], v10 offset:55296
    ds_read_b64_tr_b16 v[206:207], v10 offset:55808
    s_waitcnt lgkmcnt(10)
    v_mfma_f32_32x32x16_bf16 v[160:175], v[156:159], v[220:223], v[160:175]
    ds_read_b64_tr_b16 v[208:209], v10 offset:57344
    ds_read_b64_tr_b16 v[210:211], v10 offset:57856
L_t8j:
    s_waitcnt lgkmcnt(10)
    v_mfma_f32_32x32x16_bf16 v[176:191], v[128:131], v[192:195], 0
    ds_read_b64_tr_b16 v[212:213], v10 offset:59392
    ds_read_b64_tr_b16 v[214:215], v10 offset:59904
    s_waitcnt lgkmcnt(10)
    v_mfma_f32_32x32x16_bf16 v[176:191], v[132:135], v[196:199], v[176:191]
    ds_read_b64_tr_b16 v[216:217], v10 offset:61440
    ds_read_b64_tr_b16 v[218:219], v10 offset:61952
    s_nop 1
    v_cvt_pk_bf16_f32 v232, v160, v161
    v_cvt_pk_bf16_f32 v233, v162, v163
    v_cvt_pk_bf16_f32 v234, v164, v165
    v_cvt_pk_bf16_f32 v235, v166, v167
    s_waitcnt lgkmcnt(8)
    v_mfma_f32_32x32x16_bf16 v[176:191], v[136:139], v[200:203], v[176:191]
    ds_read_b64_tr_b16 v[220:221], v10 offset:63488
    ds_read_b64_tr_b16 v[222:223], v10 offset:64000
    v_cvt_pk_bf16_f32 v236, v168, v169
    v_cvt_pk_bf16_f32 v237, v170, v171
    v_cvt_pk_bf16_f32 v238, v172, v173
    v_cvt_pk_bf16_f32 v239, v174, v175
    s_waitcnt lgkmcnt(8)
    v_mfma_f32_32x32x16_bf16 v[176:191], v[140:143], v[204:207], v[176:191]
    s_barrier
    ds_read_b64_tr_b16 v[192:193], v12 offset:0
    ds_read_b64_tr_b16 v[194:195], v12 offset:512
    v_mfma_f32_32x32x16_bf16 v[240:255], v[232:235], v[224:227], 0
    v_mfma_f32_32x32x16_bf16 v[240:255], v[236:239], v[228:231], v[240:255]
    s_waitcnt lgkmcnt(8)
    v_mfma_f32_32x32x16_bf16 v[176:191], v[144:147], v[208:211], v[176:191]
    ds_read_b64_tr_b16 v[196:197], v12 offset:2048
    ds_read_b64_tr_b16 v[198:199], v12 offset:2560
    s_waitcnt lgkmcnt(8)
    v_mfma_f32_32x32x16_bf16 v[176:191], v[148:151], v[212:215], v[176:191]
    ds_read_b64_tr_b16 v[200:201], v12 offset:4096
    ds_read_b64_tr_b16 v[202:203], v12 offset:4608
    s_nop 3
    v_cvt_pk_bf16_f32 v32, v240, v241
    v_cvt_pk_bf16_f32 v33, v242, v243
    v_cvt_pk_bf16_f32 v34, v244, v245
    v_cvt_pk_bf16_f32 v35, v246, v247
    v_xor_b32 v32, v32, v4
    v_xor_b32 v33, v33, v5
    v_xor_b32 v34, v34, v6
    v_xor_b32 v35, v35, v7
    s_waitcnt lgkmcnt(8)
    v_mfma_f32_32x32x16_bf16 v[176:191], v[152:155], v[216:219], v[176:191]
    ds_read_b64_tr_b16 v[204:205], v12 offset:6144
    ds_read_b64_tr_b16 v[206:207], v12 offset:6656
    v_cvt_pk_bf16_f32 v36, v248, v249
    v_cvt_pk_bf16_f32 v37, v250, v251
    v_cvt_pk_bf16_f32 v38, v252, v253
    v_cvt_pk_bf16_f32 v39, v254, v255
    v_xor_b32 v36, v36, v4
    v_xor_b32 v37, v37, v5
    v_xor_b32 v38, v38, v6
    v_xor_b32 v39, v39, v7
    s_waitcnt lgkmcnt(8)
    v_mfma_f32_32x32x16_bf16 v[176:191], v[156:159], v[220:223], v[176:191]
    ds_read_b64_tr_b16 v[208:209], v12 offset:8192
    ds_read_b64_tr_b16 v[210:211], v12 offset:8704
    buffer_store_dwordx4 v[32:35], v26, s[56:59], s18 offen offset:0 sc1
    buffer_store_dwordx4 v[36:39], v26, s[56:59], s18 offen offset:128 sc1
    s_waitcnt lgkmcnt(8)
    v_mfma_f32_32x32x16_bf16 v[160:175], v[128:131], v[192:195], 0
    ds_read_b64_tr_b16 v[212:213], v12 offset:10240
    ds_read_b64_tr_b16 v[214:215], v12 offset:10752
    s_waitcnt lgkmcnt(8)
    v_mfma_f32_32x32x16_bf16 v[160:175], v[132:135], v[196:199], v[160:175]
    ds_read_b64_tr_b16 v[216:217], v12 offset:12288
    ds_read_b64_tr_b16 v[218:219], v12 offset:12800
    v_cvt_pk_bf16_f32 v80, v176, v177
    v_cvt_pk_bf16_f32 v81, v178, v179
    v_cvt_pk_bf16_f32 v82, v180, v181
    v_cvt_pk_bf16_f32 v83, v182, v183
    s_waitcnt lgkmcnt(8)
    v_mfma_f32_32x32x16_bf16 v[160:175], v[136:139], v[200:203], v[160:175]
    ds_read_b64_tr_b16 v[220:221], v12 offset:14336
    ds_read_b64_tr_b16 v[222:223], v12 offset:14848
    v_cvt_pk_bf16_f32 v84, v184, v185
    v_cvt_pk_bf16_f32 v85, v186, v187
    v_cvt_pk_bf16_f32 v86, v188, v189
    v_cvt_pk_bf16_f32 v87, v190, v191
    s_waitcnt lgkmcnt(8)
    v_mfma_f32_32x32x16_bf16 v[160:175], v[140:143], v[204:207], v[160:175]
    s_barrier
    ds_read_b64_tr_b16 v[192:193], v11 offset:0
    ds_read_b64_tr_b16 v[194:195], v11 offset:512
    s_waitcnt lgkmcnt(8)
    v_mfma_f32_32x32x16_bf16 v[160:175], v[144:147], v[208:211], v[160:175]
    ds_read_b64_tr_b16 v[196:197], v11 offset:2048
    ds_read_b64_tr_b16 v[198:199], v11 offset:2560
    s_waitcnt lgkmcnt(8)
    v_mfma_f32_32x32x16_bf16 v[160:175], v[148:151], v[212:215], v[160:175]
    ds_read_b64_tr_b16 v[200:201], v11 offset:4096
    ds_read_b64_tr_b16 v[202:203], v11 offset:4608
    s_waitcnt lgkmcnt(8)
    v_mfma_f32_32x32x16_bf16 v[160:175], v[152:155], v[216:219], v[160:175]
    ds_read_b64_tr_b16 v[204:205], v11 offset:6144
    ds_read_b64_tr_b16 v[206:207], v11 offset:6656
    s_waitcnt lgkmcnt(8)
    v_mfma_f32_32x32x16_bf16 v[160:175], v[156:159], v[220:223], v[160:175]
    ds_read_b64_tr_b16 v[208:209], v11 offset:8192
    ds_read_b64_tr_b16 v[210:211], v11 offset:8704
    s_waitcnt lgkmcnt(8)
    v_mfma_f32_32x32x16_bf16 v[176:191], v[96:99], v[192:195], 0
    ds_read_b64_tr_b16 v[212:213], v11 offset:10240
    ds_read_b64_tr_b16 v[214:215], v11 offset:10752
    s_waitcnt lgkmcnt(8)
    v_mfma_f32_32x32x16_bf16 v[176:191], v[100:103], v[196:199], v[176:191]
    ds_read_b64_tr_b16 v[216:217], v11 offset:12288
    ds_read_b64_tr_b16 v[218:219], v11 offset:12800
    s_nop 1
    v_cvt_pk_bf16_f32 v88, v160, v161
    v_cvt_pk_bf16_f32 v89, v162, v163
    v_cvt_pk_bf16_f32 v90, v164, v165
    v_cvt_pk_bf16_f32 v91, v166, v167
    s_waitcnt lgkmcnt(8)
    v_mfma_f32_32x32x16_bf16 v[176:191], v[104:107], v[200:203], v[176:191]
    ds_read_b64_tr_b16 v[220:221], v11 offset:14336
    ds_read_b64_tr_b16 v[222:223], v11 offset:14848
    v_cvt_pk_bf16_f32 v92, v168, v169
    v_cvt_pk_bf16_f32 v93, v170, v171
    v_cvt_pk_bf16_f32 v94, v172, v173
    v_cvt_pk_bf16_f32 v95, v174, v175
    s_waitcnt lgkmcnt(8)
    v_mfma_f32_32x32x16_bf16 v[176:191], v[108:111], v[204:207], v[176:191]
    s_barrier
    ds_read_b64_tr_b16 v[192:193], v11 offset:16384
    ds_read_b64_tr_b16 v[194:195], v11 offset:16896
    s_waitcnt lgkmcnt(8)
    v_mfma_f32_32x32x16_bf16 v[176:191], v[112:115], v[208:211], v[176:191]
    ds_read_b64_tr_b16 v[196:197], v11 offset:18432
    ds_read_b64_tr_b16 v[198:199], v11 offset:18944
    s_waitcnt lgkmcnt(8)
    v_mfma_f32_32x32x16_bf16 v[176:191], v[116:119], v[212:215], v[176:191]
    ds_read_b64_tr_b16 v[200:201], v11 offset:20480
    ds_read_b64_tr_b16 v[202:203], v11 offset:20992
    s_waitcnt lgkmcnt(8)
    v_mfma_f32_32x32x16_bf16 v[176:191], v[120:123], v[216:219], v[176:191]
    ds_read_b64_tr_b16 v[204:205], v11 offset:22528
    ds_read_b64_tr_b16 v[206:207], v11 offset:23040
    s_waitcnt lgkmcnt(8)
    v_mfma_f32_32x32x16_bf16 v[176:191], v[124:127], v[220:223], v[176:191]
    ds_read_b64_tr_b16 v[208:209], v11 offset:24576
    ds_read_b64_tr_b16 v[210:211], v11 offset:25088
    s_waitcnt lgkmcnt(8)
    v_mfma_f32_32x32x16_bf16 v[160:175], v[96:99], v[192:195], 0
    ds_read_b64_tr_b16 v[212:213], v11 offset:26624
    ds_read_b64_tr_b16 v[214:215], v11 offset:27136
    s_waitcnt lgkmcnt(8)
    v_mfma_f32_32x32x16_bf16 v[160:175], v[100:103], v[196:199], v[160:175]
    ds_read_b64_tr_b16 v[216:217], v11 offset:28672
    ds_read_b64_tr_b16 v[218:219], v11 offset:29184
    s_nop 1
    v_cvt_pk_bf16_f32 v14, v176, v177
    v_cvt_pk_bf16_f32 v15, v178, v179
    v_cvt_pk_bf16_f32 v16, v180, v181
    v_cvt_pk_bf16_f32 v17, v182, v183
    s_waitcnt lgkmcnt(8)
    v_mfma_f32_32x32x16_bf16 v[160:175], v[104:107], v[200:203], v[160:175]
    ds_read_b64_tr_b16 v[220:221], v11 offset:30720
    ds_read_b64_tr_b16 v[222:223], v11 offset:31232
    v_cvt_pk_bf16_f32 v18, v184, v185
    v_cvt_pk_bf16_f32 v19, v186, v187
    v_cvt_pk_bf16_f32 v20, v188, v189
    v_cvt_pk_bf16_f32 v21, v190, v191
    s_waitcnt lgkmcnt(8)
    v_mfma_f32_32x32x16_bf16 v[160:175], v[108:111], v[204:207], v[160:175]
    s_barrier
    ds_read_b64_tr_b16 v[192:193], v12 offset:16384
    ds_read_b64_tr_b16 v[194:195], v12 offset:16896
    ds_read_b128 v[224:227], v23 offset:0
    ds_read_b128 v[228:231], v23 offset:512
    s_waitcnt lgkmcnt(10)
    v_mfma_f32_32x32x16_bf16 v[160:175], v[112:115], v[208:211], v[160:175]
    ds_read_b64_tr_b16 v[196:197], v12 offset:18432
    ds_read_b64_tr_b16 v[198:199], v12 offset:18944
    ds_read_b128 v[232:235], v23 offset:1024
    ds_read_b128 v[236:239], v23 offset:1536
    s_waitcnt lgkmcnt(12)
    v_mfma_f32_32x32x16_bf16 v[160:175], v[116:119], v[212:215], v[160:175]
    ds_read_b64_tr_b16 v[200:201], v12 offset:20480
    ds_read_b64_tr_b16 v[202:203], v12 offset:20992
    ds_read_b128 v[240:243], v23 offset:2048
    s_waitcnt lgkmcnt(14)
    ds_read_b128 v[244:247], v23 offset:2560
    s_waitcnt lgkmcnt(8)
    v_mfma_f32_32x32x16_bf16 v[48:63], v[64:67], v[224:227], 0
    v_mfma_f32_32x32x16_bf16 v[48:63], v[68:71], v[228:231], v[48:63]
    v_mfma_f32_32x32x16_bf16 v[160:175], v[120:123], v[216:219], v[160:175]
    ds_read_b64_tr_b16 v[204:205], v12 offset:22528
    ds_read_b64_tr_b16 v[206:207], v12 offset:23040
    ds_read_b128 v[248:251], v23 offset:3072
    ds_read_b128 v[252:255], v23 offset:3584
    s_waitcnt lgkmcnt(8)
    v_mfma_f32_32x32x16_bf16 v[48:63], v[72:75], v[232:235], v[48:63]
    v_mfma_f32_32x32x16_bf16 v[48:63], v[76:79], v[236:239], v[48:63]
    v_mfma_f32_32x32x16_bf16 v[160:175], v[124:127], v[220:223], v[160:175]
    ds_read_b64_tr_b16 v[208:209], v12 offset:24576
    ds_read_b64_tr_b16 v[210:211], v12 offset:25088
    s_waitcnt lgkmcnt(6)
    v_mfma_f32_32x32x16_bf16 v[48:63], v[80:83], v[240:243], v[48:63]
    v_mfma_f32_32x32x16_bf16 v[48:63], v[84:87], v[244:247], v[48:63]
    v_mfma_f32_32x32x16_bf16 v[176:191], v[128:131], v[192:195], 0
    ds_read_b64_tr_b16 v[212:213], v12 offset:26624
    ds_read_b64_tr_b16 v[214:215], v12 offset:27136
    s_waitcnt lgkmcnt(4)
    v_mfma_f32_32x32x16_bf16 v[48:63], v[88:91], v[248:251], v[48:63]
    v_mfma_f32_32x32x16_bf16 v[48:63], v[92:95], v[252:255], v[48:63]
    v_mfma_f32_32x32x16_bf16 v[176:191], v[132:135], v[196:199], v[176:191]
    ds_read_b64_tr_b16 v[216:217], v12 offset:28672
    ds_read_b64_tr_b16 v[218:219], v12 offset:29184
    v_cvt_pk_bf16_f32 v96, v160, v161
    v_cvt_pk_bf16_f32 v97, v162, v163
    v_cvt_pk_bf16_f32 v98, v164, v165
    v_cvt_pk_bf16_f32 v99, v166, v167
    v_mfma_f32_32x32x16_bf16 v[64:79], v[14:17], v[224:227], 0
    v_mfma_f32_32x32x16_bf16 v[64:79], v[18:21], v[228:231], v[64:79]
    v_mfma_f32_32x32x16_bf16 v[176:191], v[136:139], v[200:203], v[176:191]
    ds_read_b64_tr_b16 v[220:221], v12 offset:30720
    ds_read_b64_tr_b16 v[222:223], v12 offset:31232
    v_cvt_pk_bf16_f32 v100, v168, v169
    v_cvt_pk_bf16_f32 v101, v170, v171
    v_cvt_pk_bf16_f32 v102, v172, v173
    v_cvt_pk_bf16_f32 v103, v174, v175
    v_cvt_pk_bf16_f32 v32, v48, v49
    v_cvt_pk_bf16_f32 v33, v50, v51
    v_cvt_pk_bf16_f32 v34, v52, v53
    v_cvt_pk_bf16_f32 v35, v54, v55
    v_cvt_pk_bf16_f32 v36, v56, v57
    v_cvt_pk_bf16_f32 v37, v58, v59
    v_cvt_pk_bf16_f32 v38, v60, v61
    v_cvt_pk_bf16_f32 v39, v62, v63
    v_xor_b32 v32, v32, v4
    v_xor_b32 v33, v33, v5
    v_xor_b32 v34, v34, v6
    v_xor_b32 v35, v35, v7
    v_xor_b32 v36, v36, v4
    v_xor_b32 v37, v37, v5
    v_xor_b32 v38, v38, v6
    v_xor_b32 v39, v39, v7
    buffer_store_dwordx4 v[32:35], v25, s[56:59], s17 offen offset:0 sc1
    buffer_store_dwordx4 v[36:39], v25, s[56:59], s17 offen offset:128 sc1
    s_add_u32 s17, s17, 8192
    v_mfma_f32_32x32x16_bf16 v[176:191], v[140:143], v[204:207], v[176:191]
    s_barrier
    ds_read_b64_tr_b16 v[192:193], v10 offset:0
    ds_read_b64_tr_b16 v[194:195], v10 offset:512
    v_mfma_f32_32x32x16_bf16 v[64:79], v[96:99], v[232:235], v[64:79]
    v_mfma_f32_32x32x16_bf16 v[64:79], v[100:103], v[236:239], v[64:79]
    s_waitcnt lgkmcnt(8)
    v_mfma_f32_32x32x16_bf16 v[176:191], v[144:147], v[208:211], v[176:191]
    ds_read_b64_tr_b16 v[196:197], v10 offset:2048
    ds_read_b64_tr_b16 v[198:199], v10 offset:2560
    s_waitcnt lgkmcnt(8)
    v_mfma_f32_32x32x16_bf16 v[176:191], v[148:151], v[212:215], v[176:191]
    ds_read_b64_tr_b16 v[200:201], v10 offset:4096
    ds_read_b64_tr_b16 v[202:203], v10 offset:4608
    s_waitcnt lgkmcnt(8)
    v_mfma_f32_32x32x16_bf16 v[176:191], v[152:155], v[216:219], v[176:191]
    ds_read_b64_tr_b16 v[204:205], v10 offset:6144
    ds_read_b64_tr_b16 v[206:207], v10 offset:6656
    s_waitcnt lgkmcnt(8)
    v_mfma_f32_32x32x16_bf16 v[176:191], v[156:159], v[220:223], v[176:191]
    ds_read_b64_tr_b16 v[208:209], v10 offset:8192
    ds_read_b64_tr_b16 v[210:211], v10 offset:8704
    s_waitcnt lgkmcnt(8)
    v_mfma_f32_32x32x16_bf16 v[160:175], v[128:131], v[192:195], 0
    ds_read_b64_tr_b16 v[212:213], v10 offset:10240
    ds_read_b64_tr_b16 v[214:215], v10 offset:10752
    s_waitcnt lgkmcnt(8)
    v_mfma_f32_32x32x16_bf16 v[160:175], v[132:135], v[196:199], v[160:175]
    ds_read_b64_tr_b16 v[216:217], v10 offset:12288
    ds_read_b64_tr_b16 v[218:219], v10 offset:12800
    s_nop 1
    v_cvt_pk_bf16_f32 v104, v176, v177
    v_cvt_pk_bf16_f32 v105, v178, v179
    v_cvt_pk_bf16_f32 v106, v180, v181
    v_cvt_pk_bf16_f32 v107, v182, v183
    s_waitcnt lgkmcnt(8)
    v_mfma_f32_32x32x16_bf16 v[160:175], v[136:139], v[200:203], v[160:175]
    ds_read_b64_tr_b16 v[220:221], v10 offset:14336
    ds_read_b64_tr_b16 v[222:223], v10 offset:14848
    v_cvt_pk_bf16_f32 v108, v184, v185
    v_cvt_pk_bf16_f32 v109, v186, v187
    v_cvt_pk_bf16_f32 v110, v188, v189
    v_cvt_pk_bf16_f32 v111, v190, v191
    s_waitcnt lgkmcnt(8)
    v_mfma_f32_32x32x16_bf16 v[160:175], v[140:143], v[204:207], v[160:175]
    s_waitcnt lgkmcnt(6)
    v_mfma_f32_32x32x16_bf16 v[160:175], v[144:147], v[208:211], v[160:175]
    s_waitcnt lgkmcnt(4)
    v_mfma_f32_32x32x16_bf16 v[160:175], v[148:151], v[212:215], v[160:175]
    s_waitcnt lgkmcnt(2)
    v_mfma_f32_32x32x16_bf16 v[160:175], v[152:155], v[216:219], v[160:175]
    s_waitcnt lgkmcnt(0)
    v_mfma_f32_32x32x16_bf16 v[160:175], v[156:159], v[220:223], v[160:175]
    v_mfma_f32_32x32x16_bf16 v[64:79], v[104:107], v[240:243], v[64:79]
    v_mfma_f32_32x32x16_bf16 v[64:79], v[108:111], v[244:247], v[64:79]
    s_nop 9
    v_cvt_pk_bf16_f32 v112, v160, v161
    v_cvt_pk_bf16_f32 v113, v162, v163
    v_cvt_pk_bf16_f32 v114, v164, v165
    v_cvt_pk_bf16_f32 v115, v166, v167
    v_cvt_pk_bf16_f32 v116, v168, v169
    v_cvt_pk_bf16_f32 v117, v170, v171
    v_cvt_pk_bf16_f32 v118, v172, v173
    v_cvt_pk_bf16_f32 v119, v174, v175
    v_mfma_f32_32x32x16_bf16 v[64:79], v[112:115], v[248:251], v[64:79]
    s_nop 0
    v_mfma_f32_32x32x16_bf16 v[64:79], v[116:119], v[252:255], v[64:79]
    s_nop 11
    v_cvt_pk_bf16_f32 v32, v64, v65
    v_cvt_pk_bf16_f32 v33, v66, v67
    v_cvt_pk_bf16_f32 v34, v68, v69
    v_cvt_pk_bf16_f32 v35, v70, v71
    v_cvt_pk_bf16_f32 v36, v72, v73
    v_cvt_pk_bf16_f32 v37, v74, v75
    v_cvt_pk_bf16_f32 v38, v76, v77
    v_cvt_pk_bf16_f32 v39, v78, v79
    v_xor_b32 v32, v32, v4
    v_xor_b32 v33, v33, v5
    v_xor_b32 v34, v34, v6
    v_xor_b32 v35, v35, v7
    v_xor_b32 v36, v36, v4
    v_xor_b32 v37, v37, v5
    v_xor_b32 v38, v38, v6
    v_xor_b32 v39, v39, v7
    buffer_store_dwordx4 v[32:35], v25, s[56:59], s17 offen offset:0 sc1
    buffer_store_dwordx4 v[36:39], v25, s[56:59], s17 offen offset:128 sc1
    s_add_u32 s61, s19, 4096
    s_movk_i32 s62, 4096
    buffer_load_dwordx4 v[96:99], v27, s[56:59], s19 offen sc1
    buffer_load_dwordx4 v[100:103], v27, s[56:59], s61 offen sc1
    s_branch L_rl1_k1
L_rl1_try:
    v_or_b32_dpp v128, v128, v128 quad_perm:[1,0,3,2] row_mask:0xf bank_mask:0xf
    v_or_b32_dpp v129, v129, v129 quad_perm:[1,0,3,2] row_mask:0xf bank_mask:0xf
    s_nop 0
    v_or_b32_dpp v128, v128, v128 quad_perm:[2,3,0,1] row_mask:0xf bank_mask:0xf
    v_or_b32_dpp v129, v129, v129 quad_perm:[2,3,0,1] row_mask:0xf bank_mask:0xf
    s_nop 0
    v_or_b32_dpp v128, v128, v128 row_half_mirror row_mask:0xf bank_mask:0xf
    v_or_b32_dpp v129, v129, v129 row_half_mirror row_mask:0xf bank_mask:0xf
    v_and_b32 v128, 0x40004000, v128
    v_cmp_ne_u32 vcc, 0, v128
    v_and_b32 v129, 0x40004000, v129
    v_cmp_ne_u32 s[8:9], 0, v129
    s_mov_b64 exec, vcc
    s_cbranch_execz L_rl1_k0
    buffer_load_dwordx4 v[96:99], v27, s[56:59], s19 offen sc1
L_rl1_k0:
    s_mov_b64 exec, s[8:9]
    s_cbranch_execz L_rl1_k1
    buffer_load_dwordx4 v[100:103], v27, s[56:59], s61 offen sc1
L_rl1_k1:
    s_mov_b64 exec, -1
    s_sub_u32 s62, s62, 1
    s_waitcnt vmcnt(0)
    v_xor_b32 v112, v96, v4
    v_xor_b32 v113, v97, v5
    v_xor_b32 v114, v98, v6
    v_xor_b32 v115, v99, v7
    v_or3_b32 v128, v112, v113, v114
    v_or_b32 v128, v128, v115
    v_xor_b32 v116, v100, v4
    v_xor_b32 v117, v101, v5
    v_xor_b32 v118, v102, v6
    v_xor_b32 v119, v103, v7
    v_or3_b32 v129, v116, v117, v118
    v_or_b32 v129, v129, v119
    v_or_b32 v132, v128, v129
    v_and_b32 v132, 0x40004000, v132
    v_cmp_ne_u32 vcc, 0, v132
    s_cbranch_scc1 L_rl1_go
    s_cbranch_vccnz L_rl1_try
L_rl1_go:
    v_lshlrev_b32 v128, 16, v112
    v_and_b32 v129, 0xffff0000, v112
    v_lshlrev_b32 v130, 16, v113
    v_and_b32 v131, 0xffff0000, v113
    v_lshlrev_b32 v132, 16, v114
    v_and_b32 v133, 0xffff0000, v114
    v_lshlrev_b32 v134, 16, v115
    v_and_b32 v135, 0xffff0000, v115
    v_lshlrev_b32 v136, 16, v116
    v_and_b32 v137, 0xffff0000, v116
    v_lshlrev_b32 v138, 16, v117
    v_and_b32 v139, 0xffff0000, v117
    v_lshlrev_b32 v140, 16, v118
    v_and_b32 v141, 0xffff0000, v118
    v_lshlrev_b32 v142, 16, v119
    v_and_b32 v143, 0xffff0000, v119
    v_pk_add_f32 v[128:129], v[128:129], v[136:137]
    v_pk_add_f32 v[130:131], v[130:131], v[138:139]
    v_pk_add_f32 v[132:133], v[132:133], v[140:141]
    v_pk_add_f32 v[134:135], v[134:135], v[142:143]
    s_nop 0
    v_permlane32_swap_b32 v128, v132
    v_permlane32_swap_b32 v129, v133
    v_permlane32_swap_b32 v130, v134
    v_permlane32_swap_b32 v131, v135
    v_pk_add_f32 v[128:129], v[128:129], v[132:133]
    v_pk_add_f32 v[130:131], v[130:131], v[134:135]
    s_nop 1
    v_permlane16_swap_b32 v128, v130
    v_permlane16_swap_b32 v129, v131
    v_pk_add_f32 v[128:129], v[128:129], v[130:131]
    v_mul_f32 v128, 0x53800000, v128
    v_mul_f32 v129, 0x53800000, v129
    v_cvt_pk_bf16_f32 v136, v128, v129
    buffer_store_dword v136, v28, s[52:55], s20 offen
    s_mov_b64 exec, -1
L_cend:
L_end:
    s_endpgm
.section .rodata,"a"
.p2align 6
.amdhsa_kernel standalone__gqa_block_cached__near_ridge_kernel
  .amdhsa_next_free_vgpr 256
  .amdhsa_next_free_sgpr 102
  .amdhsa_accum_offset 256
  .amdhsa_group_segment_fixed_size 0
  .amdhsa_kernarg_size 64
  .amdhsa_user_sgpr_count 2
  .amdhsa_user_sgpr_kernarg_segment_ptr 1
  .amdhsa_system_sgpr_workgroup_id_x 1
.end_amdhsa_kernel
```
